```python
import torch

def _softmax(x, axis=-1):
    return torch.softmax(x, dim=axis)
def _gelu(x):
    return torch.nn.functional.gelu(x, approximate="tanh")
def _silu(x):
    return torch.nn.functional.silu(x)
def _sigmoid(x):
    return torch.sigmoid(x)
def _layernorm(x, axis=-1, eps=1e-5):
    m = x.mean(dim=axis, keepdim=True)
    v = x.var(dim=axis, keepdim=True, unbiased=False)
    return (x - m) / torch.sqrt(v + eps)
def _scatter_add(tgt, idx, src, axis=0):
    return tgt.clone().index_add_(axis, idx, src)
def _segment_sum(src, seg, n):
    out = torch.zeros((n,) + src.shape[1:], dtype=src.dtype)
    return out.index_add_(0, seg, src)
def _pad(x, pw):
    flat = tuple(v for pair in reversed(pw) for v in pair)
    return torch.nn.functional.pad(x, flat)

kernel_name = 'gated_mix__mha_block__ssm_conv_h3__prompt'

def setup_inputs():

    _w = (lambda a: (lambda t: t.to(torch.bfloat16) if t.is_floating_point() else t)(torch.as_tensor(a)))
    def _A_setup():
        B, S, D, H = 1, 2048, 576, 32
        return {
            "x": _w((lambda *s: torch.randn(*s, dtype=torch.bfloat16) * 0.05)(B, S, D)),
            "wqkv": _w((lambda *s: torch.randn(*s, dtype=torch.bfloat16) * 0.8)(D, 3 * D)),
            "wo": _w((lambda *s: torch.randn(*s, dtype=torch.bfloat16) * 0.05)(D, D)),
        }
    _A_in = _A_setup()

    def _B_setup():
        B, S, D = 1, 2048, 576
        ks = 4
        return {
            "q": _w((lambda *s: torch.randn(*s, dtype=torch.bfloat16) * 0.05)(B, S, D)),
            "k": _w((lambda *s: torch.randn(*s, dtype=torch.bfloat16) * 0.4)(B, S, D)),
            "v": _w((lambda *s: torch.randn(*s, dtype=torch.bfloat16) * 0.4)(B, S, D)),
            "shift_k": _w((lambda *s: torch.randn(*s, dtype=torch.bfloat16) * 0.4)(D, ks) * 0.5),
            "ssm_k": _w((lambda *s: torch.randn(*s, dtype=torch.bfloat16) * 1.6)(D, S) * (1.0 / S ** 0.5)),
            "ssm_D": _w((lambda *s: torch.randn(*s, dtype=torch.bfloat16) * 0.4)(D)),
        }
    _B_in = _B_setup()

    return {
        "A_x": _A_in["x"],
        "A_wqkv": _A_in["wqkv"],
        "A_wo": _A_in["wo"],
        "B_q": _B_in["q"],
        "B_k": _B_in["k"],
        "B_v": _B_in["v"],
        "B_shift_k": _B_in["shift_k"],
        "B_ssm_k": _B_in["ssm_k"],
        "B_ssm_D": _B_in["ssm_D"],
        "gate_w": _w((lambda *s: torch.randn(*s, dtype=torch.bfloat16) * 0.05)(576) * 16.0),
    }

def reference(A_x, A_wqkv, A_wo, B_q, B_k, B_v, B_shift_k, B_ssm_k, B_ssm_D, gate_w):
    def _A_ref(x, wqkv, wo):
        B, S, D = x.shape
        H = 32
        Dh = D // H
        qkv = (lambda x, *d: x.permute(*d))((x @ wqkv).reshape(B, S, 3, H, Dh), 2, 0, 3, 1, 4)
        q, k, v = qkv[0], qkv[1], qkv[2]
        scores = torch.einsum("bhqd,bhkd->bhqk", q, k) * (Dh ** -0.5)
        p = _softmax(scores, axis=-1)
        o = torch.einsum("bhqk,bhkd->bhqd", p, v)
        return (lambda x, *d: x.permute(*d))(o, 0, 2, 1, 3).reshape(B, S, D) @ wo

    def _B_ref(q, k, v, shift_k, ssm_k, ssm_D):
        B, S, D = q.shape
        ks = shift_k.shape[-1]
        k_pad = _pad(k, ((0, 0), (ks - 1, 0), (0, 0)))
        k_shift = torch.zeros_like(k)
        for t in range(ks):
            k_shift = k_shift + k_pad[:, t:t + S, :] * shift_k[:, ks - 1 - t][None, None, :]
        kv = k_shift * v
        L = 2 * S
        kv_pad = _pad(kv, ((0, 0), (0, S), (0, 0)))
        kf_pad = _pad(ssm_k, ((0, 0), (0, S)))
        kv_f = (lambda x, axes=(-2,-1): torch.fft.rfft2(x.float(), dim=axes))(kv_pad[:, None, :, :], axes=(1, 2))
        kf_f = (lambda x, axes=(-2,-1): torch.fft.rfft2(x.float(), dim=axes))(kf_pad[:, None, :], axes=(1, 2))
        kf_f = (lambda x, *d: x.permute(*d))(kf_f, 1, 2, 0)
        y_f = kv_f * kf_f[None, :, :, :]
        y = (lambda x, s, axes=(-2,-1): torch.fft.irfft2(x, s=s, dim=axes).to(torch.bfloat16))(y_f, (1, L), axes=(1, 2))[:, 0, :S, :]
        y = y + kv * ssm_D[None, None, :]
        return q * y

    x = A_x
    g = _sigmoid((x * gate_w).sum(-1, keepdims=True))
    a = _A_ref(x, A_wqkv, A_wo)
    b = _B_ref(x, B_k, B_v, B_shift_k, B_ssm_k, B_ssm_D)
    return g * a + (1 - g) * b
```

```asm
; @launch grid=(256,1,1) block=(768,1,1) lds=161408
.amdgcn_target "amdgcn-amd-amdhsa--gfx950"
.text
.globl gated_mix__mha_block__ssm_conv_h3__prompt_kernel
.p2align 8
.type gated_mix__mha_block__ssm_conv_h3__prompt_kernel,@function
gated_mix__mha_block__ssm_conv_h3__prompt_kernel:
  s_cmp_ge_u32 s2, 256
  s_cbranch_scc1 L_end
  s_load_dwordx4 s[4:7], s[0:1], 0
  s_load_dwordx4 s[8:11], s[0:1], 32
  s_load_dwordx2 s[12:13], s[0:1], 48
  s_load_dwordx2 s[14:15], s[0:1], 96
  s_and_b32 s40, s2, 1
  s_lshl_b32 s40, s40, 3
  s_lshr_b32 s43, s2, 3
  s_and_b32 s43, s43, 7
  s_add_u32 s40, s40, s43
  s_lshr_b32 s41, s2, 1
  s_and_b32 s41, s41, 3
  s_lshl_b32 s41, s41, 2
  s_lshr_b32 s43, s2, 6
  s_add_u32 s41, s41, s43
  v_lshrrev_b32 v1, 6, v0
  v_and_b32 v2, 63, v0
  v_readfirstlane_b32 s42, v1
  v_and_b32 v3, 15, v2
  v_lshrrev_b32 v4, 4, v2
  s_cmp_ge_u32 s42, 8
  s_cbranch_scc0 L1_gemm
  s_waitcnt lgkmcnt(0)
  s_mov_b32 s36, s14
  s_and_b32 s37, s15, 0xffff
  s_mov_b32 s38, 0x2000000
  s_mov_b32 s39, 0x20000
  s_branch L1_side
L1_gemm:
  v_lshrrev_b32 v5, 3, v2
  v_and_b32 v6, 7, v2
  s_lshl_b32 s43, s41, 7
  s_lshl_b32 s44, s42, 4
  s_add_u32 s43, s43, s44
  v_add_u32 v5, s43, v5
  s_movk_i32 s44, 1152
  v_mul_lo_u32 v5, v5, s44
  v_xor_b32 v7, v6, v4
  v_lshl_add_u32 v8, v7, 4, v5
  v_xor_b32 v7, 4, v7
  v_lshl_add_u32 v9, v7, 4, v5
  v_add_u32 v9, 9216, v9
  s_and_b32 s44, s42, 1
  s_lshl_b32 s44, s44, 3
  v_lshlrev_b32 v5, 1, v4
  v_add_u32 v5, s44, v5
  v_xor_b32 v5, v5, v3
  v_min_u32 v5, 13, v5
  s_movk_i32 s44, 3456
  v_mul_lo_u32 v6, v4, s44
  v_lshl_add_u32 v10, v5, 4, v6
  s_mul_i32 s45, s40, 216
  s_mul_i32 s46, s42, 8*3456
  s_add_u32 s46, s46, s45
  s_mov_b32 s47, 0
  s_lshl_b32 s48, s42, 11
  s_waitcnt lgkmcnt(0)
  s_mov_b32 s16, s4
  s_and_b32 s17, s5, 0xffff
  s_mov_b32 s18, 0x240000
  s_mov_b32 s19, 0x20000
  s_mov_b32 s20, s6
  s_and_b32 s21, s7, 0xffff
  s_mov_b32 s22, 0x1e6000
  s_mov_b32 s23, 0x20000
  s_mov_b32 s36, s14
  s_and_b32 s37, s15, 0xffff
  s_mov_b32 s38, 0x2000000
  s_mov_b32 s39, 0x20000
  s_mov_b32 m0, s48
  s_add_u32 s49, s48, 1024
  buffer_load_dwordx4 v8, s[16:19], s47 offen lds
  s_mov_b32 m0, s49
  s_add_u32 s49, s48, 16384
  buffer_load_dwordx4 v9, s[16:19], s47 offen lds
  s_mov_b32 m0, s49
  s_add_u32 s49, s48, 17408
  buffer_load_dwordx4 v10, s[20:23], s46 offen lds
  s_mov_b32 m0, s49
  s_add_u32 s50, s46, 4*3456
  buffer_load_dwordx4 v10, s[20:23], s50 offen lds
  s_add_u32 s46, s46, 64*3456
  s_add_u32 s47, s47, 128
  s_add_u32 s48, s48, 32768
  s_and_b32 s48, s48, 0x1ffff
  s_and_b32 s51, s42, 3
  s_lshr_b32 s52, s42, 2
  s_lshl_b32 s44, s51, 5
  v_add_u32 v5, s44, v3
  v_lshlrev_b32 v5, 7, v5
  v_lshrrev_b32 v6, 1, v3
  v_xor_b32 v6, v6, v4
  v_lshl_add_u32 v11, v6, 4, v5
  v_xor_b32 v12, 64, v11
  v_add_u32 v13, 0x10000, v11
  v_add_u32 v14, 0x10000, v12
  v_lshrrev_b32 v6, 2, v2
  v_and_b32 v6, 3, v6
  v_and_b32 v7, 3, v2
  v_lshl_add_u32 v1, v4, 3, v6
  v_lshlrev_b32 v1, 8, v1
  v_and_b32 v5, 1, v7
  v_lshl_add_u32 v1, v5, 3, v1
  v_lshrrev_b32 v7, 1, v7
  v_lshl_add_u32 v1, v7, 4, v1
  v_add_u32 v1, 16384, v1
  v_and_b32 v5, 1, v4
  v_lshlrev_b32 v5, 3, v5
  v_lshl_add_u32 v5, v6, 1, v5
  s_lshl_b32 s44, s52, 3
  s_add_u32 s45, s44, 0
  v_xor_b32 v6, s45, v5
  v_lshl_add_u32 v16, v6, 4, v1
  v_add_u32 v20, 0x10000, v16
  s_add_u32 s45, s44, 2
  v_xor_b32 v6, s45, v5
  v_lshl_add_u32 v17, v6, 4, v1
  v_add_u32 v21, 0x10000, v17
  s_add_u32 s45, s44, 4
  v_xor_b32 v6, s45, v5
  v_lshl_add_u32 v18, v6, 4, v1
  v_add_u32 v22, 0x10000, v18
  s_add_u32 s45, s44, 6
  v_xor_b32 v6, s45, v5
  v_lshl_add_u32 v19, v6, 4, v1
  v_add_u32 v23, 0x10000, v19
  s_mov_b32 m0, s48
  s_add_u32 s49, s48, 1024
  buffer_load_dwordx4 v8, s[16:19], s47 offen lds
  s_mov_b32 m0, s49
  s_add_u32 s49, s48, 16384
  buffer_load_dwordx4 v9, s[16:19], s47 offen lds
  s_mov_b32 m0, s49
  s_add_u32 s49, s48, 17408
  buffer_load_dwordx4 v10, s[20:23], s46 offen lds
  s_mov_b32 m0, s49
  s_add_u32 s50, s46, 4*3456
  buffer_load_dwordx4 v10, s[20:23], s50 offen lds
  s_add_u32 s46, s46, 64*3456
  s_add_u32 s47, s47, 128
  s_add_u32 s48, s48, 32768
  s_and_b32 s48, s48, 0x1ffff
  s_lshl_b32 s44, s51, 5
  v_add_u32 v5, s44, v3
  s_movk_i32 s44, 304
  v_mul_lo_u32 v5, v5, s44
  s_mul_i32 s44, s40, 6
  s_sub_i32 s44, 32, s44
  s_max_i32 s44, s44, 0
  s_min_i32 s44, s44, 6
  s_mul_i32 s54, s44, 18
  s_lshl_b32 s55, s52, 6
  v_lshl_add_u32 v6, v4, 2, s55
  s_movk_i32 s56, 3641
  v_mov_b32 v24, 1.0
  v_mov_b32 v25, 0x3eae1a93
  v_add_u32 v26, 0, v6
  v_min_u32 v26, 110, v26
  v_mul_u32_u24 v27, s56, v26
  v_cmp_gt_u32 vcc, s54, v26
  v_lshrrev_b32 v27, 16, v27
  v_mul_u32_u24 v27, 12, v27
  v_cndmask_b32 v120, v24, v25, vcc
  v_lshl_add_u32 v27, v26, 1, v27
  v_add_u32 v112, v27, v5
  v_add_u32 v112, 32768, v112
  v_add_u32 v26, 2, v6
  v_min_u32 v26, 110, v26
  v_mul_u32_u24 v27, s56, v26
  v_cmp_gt_u32 vcc, s54, v26
  v_lshrrev_b32 v27, 16, v27
  v_mul_u32_u24 v27, 12, v27
  v_cndmask_b32 v121, v24, v25, vcc
  v_lshl_add_u32 v27, v26, 1, v27
  v_add_u32 v113, v27, v5
  v_add_u32 v113, 32768, v113
  v_add_u32 v26, 16, v6
  v_min_u32 v26, 110, v26
  v_mul_u32_u24 v27, s56, v26
  v_cmp_gt_u32 vcc, s54, v26
  v_lshrrev_b32 v27, 16, v27
  v_mul_u32_u24 v27, 12, v27
  v_cndmask_b32 v122, v24, v25, vcc
  v_lshl_add_u32 v27, v26, 1, v27
  v_add_u32 v114, v27, v5
  v_add_u32 v114, 32768, v114
  v_add_u32 v26, 18, v6
  v_min_u32 v26, 110, v26
  v_mul_u32_u24 v27, s56, v26
  v_cmp_gt_u32 vcc, s54, v26
  v_lshrrev_b32 v27, 16, v27
  v_mul_u32_u24 v27, 12, v27
  v_cndmask_b32 v123, v24, v25, vcc
  v_lshl_add_u32 v27, v26, 1, v27
  v_add_u32 v115, v27, v5
  v_add_u32 v115, 32768, v115
  v_add_u32 v26, 32, v6
  v_min_u32 v26, 110, v26
  v_mul_u32_u24 v27, s56, v26
  v_cmp_gt_u32 vcc, s54, v26
  v_lshrrev_b32 v27, 16, v27
  v_mul_u32_u24 v27, 12, v27
  v_cndmask_b32 v124, v24, v25, vcc
  v_lshl_add_u32 v27, v26, 1, v27
  v_add_u32 v116, v27, v5
  v_add_u32 v116, 32768, v116
  v_add_u32 v26, 34, v6
  v_min_u32 v26, 110, v26
  v_mul_u32_u24 v27, s56, v26
  v_cmp_gt_u32 vcc, s54, v26
  v_lshrrev_b32 v27, 16, v27
  v_mul_u32_u24 v27, 12, v27
  v_cndmask_b32 v125, v24, v25, vcc
  v_lshl_add_u32 v27, v26, 1, v27
  v_add_u32 v117, v27, v5
  v_add_u32 v117, 32768, v117
  v_add_u32 v26, 48, v6
  v_min_u32 v26, 110, v26
  v_mul_u32_u24 v27, s56, v26
  v_cmp_gt_u32 vcc, s54, v26
  v_lshrrev_b32 v27, 16, v27
  v_mul_u32_u24 v27, 12, v27
  v_cndmask_b32 v126, v24, v25, vcc
  v_lshl_add_u32 v27, v26, 1, v27
  v_add_u32 v118, v27, v5
  v_add_u32 v118, 32768, v118
  v_add_u32 v26, 50, v6
  v_min_u32 v26, 110, v26
  v_mul_u32_u24 v27, s56, v26
  v_cmp_gt_u32 vcc, s54, v26
  v_lshrrev_b32 v27, 16, v27
  v_mul_u32_u24 v27, 12, v27
  v_cndmask_b32 v127, v24, v25, vcc
  v_lshl_add_u32 v27, v26, 1, v27
  v_add_u32 v119, v27, v5
  v_add_u32 v119, 32768, v119
  s_mov_b32 m0, s48
  s_add_u32 s49, s48, 1024
  buffer_load_dwordx4 v8, s[16:19], s47 offen lds
  s_mov_b32 m0, s49
  s_add_u32 s49, s48, 16384
  buffer_load_dwordx4 v9, s[16:19], s47 offen lds
  s_mov_b32 m0, s49
  s_add_u32 s49, s48, 17408
  buffer_load_dwordx4 v10, s[20:23], s46 offen lds
  s_mov_b32 m0, s49
  s_add_u32 s50, s46, 4*3456
  buffer_load_dwordx4 v10, s[20:23], s50 offen lds
  s_add_u32 s46, s46, 64*3456
  s_add_u32 s47, s47, 128
  s_add_u32 s48, s48, 32768
  s_and_b32 s48, s48, 0x1ffff
  s_barrier
  v_mov_b32 v28, 161340
  v_mov_b32 v29, 1
  s_waitcnt vmcnt(8)
  s_mov_b64 exec, 1
  ds_add_u32 v28, v29
  s_mov_b64 exec, -1
  ds_read_b32 v30, v28
  s_waitcnt lgkmcnt(0)
  v_readfirstlane_b32 s53, v30
  s_cmp_ge_u32 s53, 8
  s_cbranch_scc1 L1_ok0
L1_sp0:
  ds_read_b32 v30, v28
  s_waitcnt lgkmcnt(0)
  v_readfirstlane_b32 s53, v30
  s_cmp_ge_u32 s53, 8
  s_cbranch_scc1 L1_ok0
  s_sleep 1
  s_branch L1_sp0
L1_ok0:
  ds_read_b128 v[96:99], v11 offset:0
  ds_read_b128 v[100:103], v11 offset:2048
  ds_read_b64_tr_b16 v[64:65], v16 offset:0
  ds_read_b64_tr_b16 v[66:67], v16 offset:1024
  ds_read_b64_tr_b16 v[68:69], v17 offset:0
  ds_read_b64_tr_b16 v[70:71], v17 offset:1024
  ds_read_b64_tr_b16 v[72:73], v18 offset:0
  ds_read_b64_tr_b16 v[74:75], v18 offset:1024
  ds_read_b64_tr_b16 v[76:77], v19 offset:0
  ds_read_b64_tr_b16 v[78:79], v19 offset:1024
  s_waitcnt vmcnt(4)
  s_mov_b64 exec, 1
  ds_add_u32 v28, v29
  s_mov_b64 exec, -1
  s_waitcnt lgkmcnt(7)
  v_mfma_f32_16x16x32_bf16 v[32:35], v[64:67], v[96:99], 0
  ds_read_b128 v[104:107], v12 offset:0
  ds_read_b128 v[108:111], v12 offset:2048
  v_mfma_f32_16x16x32_bf16 v[36:39], v[64:67], v[100:103], 0
  ds_read_b64_tr_b16 v[80:81], v16 offset:8192
  ds_read_b64_tr_b16 v[82:83], v16 offset:9216
  s_waitcnt lgkmcnt(9)
  v_mfma_f32_16x16x32_bf16 v[40:43], v[68:71], v[96:99], 0
  ds_read_b64_tr_b16 v[84:85], v17 offset:8192
  ds_read_b64_tr_b16 v[86:87], v17 offset:9216
  v_mfma_f32_16x16x32_bf16 v[44:47], v[68:71], v[100:103], 0
  ds_read_b64_tr_b16 v[88:89], v18 offset:8192
  ds_read_b64_tr_b16 v[90:91], v18 offset:9216
  s_waitcnt lgkmcnt(11)
  v_mfma_f32_16x16x32_bf16 v[48:51], v[72:75], v[96:99], 0
  ds_read_b64_tr_b16 v[92:93], v19 offset:8192
  ds_read_b64_tr_b16 v[94:95], v19 offset:9216
  ds_read_b32 v30, v28
  v_mfma_f32_16x16x32_bf16 v[52:55], v[72:75], v[100:103], 0
  s_waitcnt lgkmcnt(12)
  v_mfma_f32_16x16x32_bf16 v[56:59], v[76:79], v[96:99], 0
  v_mfma_f32_16x16x32_bf16 v[60:63], v[76:79], v[100:103], 0
  s_waitcnt lgkmcnt(0)
  v_readfirstlane_b32 s53, v30
  s_cmp_ge_u32 s53, 16
  s_cbranch_scc1 L1_ok1
L1_sp1:
  ds_read_b32 v30, v28
  s_waitcnt lgkmcnt(0)
  v_readfirstlane_b32 s53, v30
  s_cmp_ge_u32 s53, 16
  s_cbranch_scc1 L1_ok1
  s_sleep 1
  s_branch L1_sp1
L1_ok1:
  v_mfma_f32_16x16x32_bf16 v[32:35], v[80:83], v[104:107], v[32:35]
  ds_read_b128 v[96:99], v11 offset:32768
  ds_read_b128 v[100:103], v11 offset:34816
  v_mfma_f32_16x16x32_bf16 v[36:39], v[80:83], v[108:111], v[36:39]
  ds_read_b64_tr_b16 v[64:65], v16 offset:32768
  ds_read_b64_tr_b16 v[66:67], v16 offset:33792
  v_mfma_f32_16x16x32_bf16 v[40:43], v[84:87], v[104:107], v[40:43]
  ds_read_b64_tr_b16 v[68:69], v17 offset:32768
  ds_read_b64_tr_b16 v[70:71], v17 offset:33792
  v_mfma_f32_16x16x32_bf16 v[44:47], v[84:87], v[108:111], v[44:47]
  ds_read_b64_tr_b16 v[72:73], v18 offset:32768
  ds_read_b64_tr_b16 v[74:75], v18 offset:33792
  v_mfma_f32_16x16x32_bf16 v[48:51], v[88:91], v[104:107], v[48:51]
  ds_read_b64_tr_b16 v[76:77], v19 offset:32768
  ds_read_b64_tr_b16 v[78:79], v19 offset:33792
  s_mov_b32 m0, s48
  s_add_u32 s49, s48, 1024
  buffer_load_dwordx4 v8, s[16:19], s47 offen lds
  v_mfma_f32_16x16x32_bf16 v[52:55], v[88:91], v[108:111], v[52:55]
  s_mov_b32 m0, s49
  s_add_u32 s49, s48, 16384
  buffer_load_dwordx4 v9, s[16:19], s47 offen lds
  v_mfma_f32_16x16x32_bf16 v[56:59], v[92:95], v[104:107], v[56:59]
  s_mov_b32 m0, s49
  s_add_u32 s49, s48, 17408
  buffer_load_dwordx4 v10, s[20:23], s46 offen lds
  v_mfma_f32_16x16x32_bf16 v[60:63], v[92:95], v[108:111], v[60:63]
  s_mov_b32 m0, s49
  s_add_u32 s50, s46, 4*3456
  buffer_load_dwordx4 v10, s[20:23], s50 offen lds
  s_add_u32 s46, s46, 64*3456
  s_add_u32 s47, s47, 128
  s_add_u32 s48, s48, 32768
  s_and_b32 s48, s48, 0x1ffff
  s_waitcnt vmcnt(4)
  s_mov_b64 exec, 1
  ds_add_u32 v28, v29
  s_mov_b64 exec, -1
  s_waitcnt lgkmcnt(7)
  v_mfma_f32_16x16x32_bf16 v[32:35], v[64:67], v[96:99], v[32:35]
  ds_read_b128 v[104:107], v12 offset:32768
  ds_read_b128 v[108:111], v12 offset:34816
  v_mfma_f32_16x16x32_bf16 v[36:39], v[64:67], v[100:103], v[36:39]
  ds_read_b64_tr_b16 v[80:81], v16 offset:40960
  ds_read_b64_tr_b16 v[82:83], v16 offset:41984
  s_waitcnt lgkmcnt(9)
  v_mfma_f32_16x16x32_bf16 v[40:43], v[68:71], v[96:99], v[40:43]
  ds_read_b64_tr_b16 v[84:85], v17 offset:40960
  ds_read_b64_tr_b16 v[86:87], v17 offset:41984
  v_mfma_f32_16x16x32_bf16 v[44:47], v[68:71], v[100:103], v[44:47]
  ds_read_b64_tr_b16 v[88:89], v18 offset:40960
  ds_read_b64_tr_b16 v[90:91], v18 offset:41984
  s_waitcnt lgkmcnt(11)
  v_mfma_f32_16x16x32_bf16 v[48:51], v[72:75], v[96:99], v[48:51]
  ds_read_b64_tr_b16 v[92:93], v19 offset:40960
  ds_read_b64_tr_b16 v[94:95], v19 offset:41984
  ds_read_b32 v30, v28
  v_mfma_f32_16x16x32_bf16 v[52:55], v[72:75], v[100:103], v[52:55]
  s_waitcnt lgkmcnt(12)
  v_mfma_f32_16x16x32_bf16 v[56:59], v[76:79], v[96:99], v[56:59]
  v_mfma_f32_16x16x32_bf16 v[60:63], v[76:79], v[100:103], v[60:63]
  s_waitcnt lgkmcnt(0)
  v_readfirstlane_b32 s53, v30
  s_cmp_ge_u32 s53, 24
  s_cbranch_scc1 L1_ok2
L1_sp2:
  ds_read_b32 v30, v28
  s_waitcnt lgkmcnt(0)
  v_readfirstlane_b32 s53, v30
  s_cmp_ge_u32 s53, 24
  s_cbranch_scc1 L1_ok2
  s_sleep 1
  s_branch L1_sp2
L1_ok2:
  v_mfma_f32_16x16x32_bf16 v[32:35], v[80:83], v[104:107], v[32:35]
  ds_read_b128 v[96:99], v13 offset:0
  ds_read_b128 v[100:103], v13 offset:2048
  v_mfma_f32_16x16x32_bf16 v[36:39], v[80:83], v[108:111], v[36:39]
  ds_read_b64_tr_b16 v[64:65], v20 offset:0
  ds_read_b64_tr_b16 v[66:67], v20 offset:1024
  v_mfma_f32_16x16x32_bf16 v[40:43], v[84:87], v[104:107], v[40:43]
  ds_read_b64_tr_b16 v[68:69], v21 offset:0
  ds_read_b64_tr_b16 v[70:71], v21 offset:1024
  v_mfma_f32_16x16x32_bf16 v[44:47], v[84:87], v[108:111], v[44:47]
  ds_read_b64_tr_b16 v[72:73], v22 offset:0
  ds_read_b64_tr_b16 v[74:75], v22 offset:1024
  v_mfma_f32_16x16x32_bf16 v[48:51], v[88:91], v[104:107], v[48:51]
  ds_read_b64_tr_b16 v[76:77], v23 offset:0
  ds_read_b64_tr_b16 v[78:79], v23 offset:1024
  s_mov_b32 m0, s48
  s_add_u32 s49, s48, 1024
  buffer_load_dwordx4 v8, s[16:19], s47 offen lds
  v_mfma_f32_16x16x32_bf16 v[52:55], v[88:91], v[108:111], v[52:55]
  s_mov_b32 m0, s49
  s_add_u32 s49, s48, 16384
  buffer_load_dwordx4 v9, s[16:19], s47 offen lds
  v_mfma_f32_16x16x32_bf16 v[56:59], v[92:95], v[104:107], v[56:59]
  s_mov_b32 m0, s49
  s_add_u32 s49, s48, 17408
  buffer_load_dwordx4 v10, s[20:23], s46 offen lds
  v_mfma_f32_16x16x32_bf16 v[60:63], v[92:95], v[108:111], v[60:63]
  s_mov_b32 m0, s49
  s_add_u32 s50, s46, 4*3456
  buffer_load_dwordx4 v10, s[20:23], s50 offen lds
  s_add_u32 s46, s46, 64*3456
  s_add_u32 s47, s47, 128
  s_add_u32 s48, s48, 32768
  s_and_b32 s48, s48, 0x1ffff
  s_waitcnt vmcnt(4)
  s_mov_b64 exec, 1
  ds_add_u32 v28, v29
  s_mov_b64 exec, -1
  s_waitcnt lgkmcnt(7)
  v_mfma_f32_16x16x32_bf16 v[32:35], v[64:67], v[96:99], v[32:35]
  ds_read_b128 v[104:107], v14 offset:0
  ds_read_b128 v[108:111], v14 offset:2048
  v_mfma_f32_16x16x32_bf16 v[36:39], v[64:67], v[100:103], v[36:39]
  ds_read_b64_tr_b16 v[80:81], v20 offset:8192
  ds_read_b64_tr_b16 v[82:83], v20 offset:9216
  s_waitcnt lgkmcnt(9)
  v_mfma_f32_16x16x32_bf16 v[40:43], v[68:71], v[96:99], v[40:43]
  ds_read_b64_tr_b16 v[84:85], v21 offset:8192
  ds_read_b64_tr_b16 v[86:87], v21 offset:9216
  v_mfma_f32_16x16x32_bf16 v[44:47], v[68:71], v[100:103], v[44:47]
  ds_read_b64_tr_b16 v[88:89], v22 offset:8192
  ds_read_b64_tr_b16 v[90:91], v22 offset:9216
  s_waitcnt lgkmcnt(11)
  v_mfma_f32_16x16x32_bf16 v[48:51], v[72:75], v[96:99], v[48:51]
  ds_read_b64_tr_b16 v[92:93], v23 offset:8192
  ds_read_b64_tr_b16 v[94:95], v23 offset:9216
  ds_read_b32 v30, v28
  v_mfma_f32_16x16x32_bf16 v[52:55], v[72:75], v[100:103], v[52:55]
  s_waitcnt lgkmcnt(12)
  v_mfma_f32_16x16x32_bf16 v[56:59], v[76:79], v[96:99], v[56:59]
  v_mfma_f32_16x16x32_bf16 v[60:63], v[76:79], v[100:103], v[60:63]
  s_waitcnt lgkmcnt(0)
  v_readfirstlane_b32 s53, v30
  s_cmp_ge_u32 s53, 32
  s_cbranch_scc1 L1_ok3
L1_sp3:
  ds_read_b32 v30, v28
  s_waitcnt lgkmcnt(0)
  v_readfirstlane_b32 s53, v30
  s_cmp_ge_u32 s53, 32
  s_cbranch_scc1 L1_ok3
  s_sleep 1
  s_branch L1_sp3
L1_ok3:
  v_mfma_f32_16x16x32_bf16 v[32:35], v[80:83], v[104:107], v[32:35]
  ds_read_b128 v[96:99], v13 offset:32768
  ds_read_b128 v[100:103], v13 offset:34816
  v_mfma_f32_16x16x32_bf16 v[36:39], v[80:83], v[108:111], v[36:39]
  ds_read_b64_tr_b16 v[64:65], v20 offset:32768
  ds_read_b64_tr_b16 v[66:67], v20 offset:33792
  v_mfma_f32_16x16x32_bf16 v[40:43], v[84:87], v[104:107], v[40:43]
  ds_read_b64_tr_b16 v[68:69], v21 offset:32768
  ds_read_b64_tr_b16 v[70:71], v21 offset:33792
  v_mfma_f32_16x16x32_bf16 v[44:47], v[84:87], v[108:111], v[44:47]
  ds_read_b64_tr_b16 v[72:73], v22 offset:32768
  ds_read_b64_tr_b16 v[74:75], v22 offset:33792
  v_mfma_f32_16x16x32_bf16 v[48:51], v[88:91], v[104:107], v[48:51]
  ds_read_b64_tr_b16 v[76:77], v23 offset:32768
  ds_read_b64_tr_b16 v[78:79], v23 offset:33792
  s_mov_b32 m0, s48
  s_add_u32 s49, s48, 1024
  buffer_load_dwordx4 v8, s[16:19], s47 offen lds
  v_mfma_f32_16x16x32_bf16 v[52:55], v[88:91], v[108:111], v[52:55]
  s_mov_b32 m0, s49
  s_add_u32 s49, s48, 16384
  buffer_load_dwordx4 v9, s[16:19], s47 offen lds
  v_mfma_f32_16x16x32_bf16 v[56:59], v[92:95], v[104:107], v[56:59]
  s_mov_b32 m0, s49
  s_add_u32 s49, s48, 17408
  buffer_load_dwordx4 v10, s[20:23], s46 offen lds
  v_mfma_f32_16x16x32_bf16 v[60:63], v[92:95], v[108:111], v[60:63]
  s_mov_b32 m0, s49
  s_add_u32 s50, s46, 4*3456
  buffer_load_dwordx4 v10, s[20:23], s50 offen lds
  s_add_u32 s46, s46, 64*3456
  s_add_u32 s47, s47, 128
  s_add_u32 s48, s48, 32768
  s_and_b32 s48, s48, 0x1ffff
  s_waitcnt vmcnt(4)
  s_mov_b64 exec, 1
  ds_add_u32 v28, v29
  s_mov_b64 exec, -1
  s_waitcnt lgkmcnt(7)
  v_mfma_f32_16x16x32_bf16 v[32:35], v[64:67], v[96:99], v[32:35]
  ds_read_b128 v[104:107], v14 offset:32768
  ds_read_b128 v[108:111], v14 offset:34816
  v_mfma_f32_16x16x32_bf16 v[36:39], v[64:67], v[100:103], v[36:39]
  ds_read_b64_tr_b16 v[80:81], v20 offset:40960
  ds_read_b64_tr_b16 v[82:83], v20 offset:41984
  s_waitcnt lgkmcnt(9)
  v_mfma_f32_16x16x32_bf16 v[40:43], v[68:71], v[96:99], v[40:43]
  ds_read_b64_tr_b16 v[84:85], v21 offset:40960
  ds_read_b64_tr_b16 v[86:87], v21 offset:41984
  v_mfma_f32_16x16x32_bf16 v[44:47], v[68:71], v[100:103], v[44:47]
  ds_read_b64_tr_b16 v[88:89], v22 offset:40960
  ds_read_b64_tr_b16 v[90:91], v22 offset:41984
  s_waitcnt lgkmcnt(11)
  v_mfma_f32_16x16x32_bf16 v[48:51], v[72:75], v[96:99], v[48:51]
  ds_read_b64_tr_b16 v[92:93], v23 offset:40960
  ds_read_b64_tr_b16 v[94:95], v23 offset:41984
  ds_read_b32 v30, v28
  v_mfma_f32_16x16x32_bf16 v[52:55], v[72:75], v[100:103], v[52:55]
  s_waitcnt lgkmcnt(12)
  v_mfma_f32_16x16x32_bf16 v[56:59], v[76:79], v[96:99], v[56:59]
  v_mfma_f32_16x16x32_bf16 v[60:63], v[76:79], v[100:103], v[60:63]
  s_waitcnt lgkmcnt(0)
  v_readfirstlane_b32 s53, v30
  s_cmp_ge_u32 s53, 40
  s_cbranch_scc1 L1_ok4
L1_sp4:
  ds_read_b32 v30, v28
  s_waitcnt lgkmcnt(0)
  v_readfirstlane_b32 s53, v30
  s_cmp_ge_u32 s53, 40
  s_cbranch_scc1 L1_ok4
  s_sleep 1
  s_branch L1_sp4
L1_ok4:
  v_mfma_f32_16x16x32_bf16 v[32:35], v[80:83], v[104:107], v[32:35]
  ds_read_b128 v[96:99], v11 offset:0
  ds_read_b128 v[100:103], v11 offset:2048
  v_mfma_f32_16x16x32_bf16 v[36:39], v[80:83], v[108:111], v[36:39]
  ds_read_b64_tr_b16 v[64:65], v16 offset:0
  ds_read_b64_tr_b16 v[66:67], v16 offset:1024
  v_mfma_f32_16x16x32_bf16 v[40:43], v[84:87], v[104:107], v[40:43]
  ds_read_b64_tr_b16 v[68:69], v17 offset:0
  ds_read_b64_tr_b16 v[70:71], v17 offset:1024
  v_mfma_f32_16x16x32_bf16 v[44:47], v[84:87], v[108:111], v[44:47]
  ds_read_b64_tr_b16 v[72:73], v18 offset:0
  ds_read_b64_tr_b16 v[74:75], v18 offset:1024
  v_mfma_f32_16x16x32_bf16 v[48:51], v[88:91], v[104:107], v[48:51]
  ds_read_b64_tr_b16 v[76:77], v19 offset:0
  ds_read_b64_tr_b16 v[78:79], v19 offset:1024
  s_mov_b32 m0, s48
  s_add_u32 s49, s48, 1024
  buffer_load_dwordx4 v8, s[16:19], s47 offen lds
  v_mfma_f32_16x16x32_bf16 v[52:55], v[88:91], v[108:111], v[52:55]
  s_mov_b32 m0, s49
  s_add_u32 s49, s48, 16384
  buffer_load_dwordx4 v9, s[16:19], s47 offen lds
  v_mfma_f32_16x16x32_bf16 v[56:59], v[92:95], v[104:107], v[56:59]
  s_mov_b32 m0, s49
  s_add_u32 s49, s48, 17408
  buffer_load_dwordx4 v10, s[20:23], s46 offen lds
  v_mfma_f32_16x16x32_bf16 v[60:63], v[92:95], v[108:111], v[60:63]
  s_mov_b32 m0, s49
  s_add_u32 s50, s46, 4*3456
  buffer_load_dwordx4 v10, s[20:23], s50 offen lds
  s_add_u32 s46, s46, 64*3456
  s_add_u32 s47, s47, 128
  s_add_u32 s48, s48, 32768
  s_and_b32 s48, s48, 0x1ffff
  s_waitcnt vmcnt(4)
  s_mov_b64 exec, 1
  ds_add_u32 v28, v29
  s_mov_b64 exec, -1
  s_waitcnt lgkmcnt(7)
  v_mfma_f32_16x16x32_bf16 v[32:35], v[64:67], v[96:99], v[32:35]
  ds_read_b128 v[104:107], v12 offset:0
  ds_read_b128 v[108:111], v12 offset:2048
  v_mfma_f32_16x16x32_bf16 v[36:39], v[64:67], v[100:103], v[36:39]
  ds_read_b64_tr_b16 v[80:81], v16 offset:8192
  ds_read_b64_tr_b16 v[82:83], v16 offset:9216
  s_waitcnt lgkmcnt(9)
  v_mfma_f32_16x16x32_bf16 v[40:43], v[68:71], v[96:99], v[40:43]
  ds_read_b64_tr_b16 v[84:85], v17 offset:8192
  ds_read_b64_tr_b16 v[86:87], v17 offset:9216
  v_mfma_f32_16x16x32_bf16 v[44:47], v[68:71], v[100:103], v[44:47]
  ds_read_b64_tr_b16 v[88:89], v18 offset:8192
  ds_read_b64_tr_b16 v[90:91], v18 offset:9216
  s_waitcnt lgkmcnt(11)
  v_mfma_f32_16x16x32_bf16 v[48:51], v[72:75], v[96:99], v[48:51]
  ds_read_b64_tr_b16 v[92:93], v19 offset:8192
  ds_read_b64_tr_b16 v[94:95], v19 offset:9216
  ds_read_b32 v30, v28
  v_mfma_f32_16x16x32_bf16 v[52:55], v[72:75], v[100:103], v[52:55]
  s_waitcnt lgkmcnt(12)
  v_mfma_f32_16x16x32_bf16 v[56:59], v[76:79], v[96:99], v[56:59]
  v_mfma_f32_16x16x32_bf16 v[60:63], v[76:79], v[100:103], v[60:63]
  s_waitcnt lgkmcnt(0)
  v_readfirstlane_b32 s53, v30
  s_cmp_ge_u32 s53, 48
  s_cbranch_scc1 L1_ok5
L1_sp5:
  ds_read_b32 v30, v28
  s_waitcnt lgkmcnt(0)
  v_readfirstlane_b32 s53, v30
  s_cmp_ge_u32 s53, 48
  s_cbranch_scc1 L1_ok5
  s_sleep 1
  s_branch L1_sp5
L1_ok5:
  v_mfma_f32_16x16x32_bf16 v[32:35], v[80:83], v[104:107], v[32:35]
  ds_read_b128 v[96:99], v11 offset:32768
  ds_read_b128 v[100:103], v11 offset:34816
  v_mfma_f32_16x16x32_bf16 v[36:39], v[80:83], v[108:111], v[36:39]
  ds_read_b64_tr_b16 v[64:65], v16 offset:32768
  ds_read_b64_tr_b16 v[66:67], v16 offset:33792
  v_mfma_f32_16x16x32_bf16 v[40:43], v[84:87], v[104:107], v[40:43]
  ds_read_b64_tr_b16 v[68:69], v17 offset:32768
  ds_read_b64_tr_b16 v[70:71], v17 offset:33792
  v_mfma_f32_16x16x32_bf16 v[44:47], v[84:87], v[108:111], v[44:47]
  ds_read_b64_tr_b16 v[72:73], v18 offset:32768
  ds_read_b64_tr_b16 v[74:75], v18 offset:33792
  v_mfma_f32_16x16x32_bf16 v[48:51], v[88:91], v[104:107], v[48:51]
  ds_read_b64_tr_b16 v[76:77], v19 offset:32768
  ds_read_b64_tr_b16 v[78:79], v19 offset:33792
  s_mov_b32 m0, s48
  s_add_u32 s49, s48, 1024
  buffer_load_dwordx4 v8, s[16:19], s47 offen lds
  v_mfma_f32_16x16x32_bf16 v[52:55], v[88:91], v[108:111], v[52:55]
  s_mov_b32 m0, s49
  s_add_u32 s49, s48, 16384
  buffer_load_dwordx4 v9, s[16:19], s47 offen lds
  v_mfma_f32_16x16x32_bf16 v[56:59], v[92:95], v[104:107], v[56:59]
  s_mov_b32 m0, s49
  s_add_u32 s49, s48, 17408
  buffer_load_dwordx4 v10, s[20:23], s46 offen lds
  v_mfma_f32_16x16x32_bf16 v[60:63], v[92:95], v[108:111], v[60:63]
  s_mov_b32 m0, s49
  s_add_u32 s50, s46, 4*3456
  buffer_load_dwordx4 v10, s[20:23], s50 offen lds
  s_add_u32 s46, s46, 64*3456
  s_add_u32 s47, s47, 128
  s_add_u32 s48, s48, 32768
  s_and_b32 s48, s48, 0x1ffff
  s_waitcnt vmcnt(4)
  s_mov_b64 exec, 1
  ds_add_u32 v28, v29
  s_mov_b64 exec, -1
  s_waitcnt lgkmcnt(7)
  v_mfma_f32_16x16x32_bf16 v[32:35], v[64:67], v[96:99], v[32:35]
  ds_read_b128 v[104:107], v12 offset:32768
  ds_read_b128 v[108:111], v12 offset:34816
  v_mfma_f32_16x16x32_bf16 v[36:39], v[64:67], v[100:103], v[36:39]
  ds_read_b64_tr_b16 v[80:81], v16 offset:40960
  ds_read_b64_tr_b16 v[82:83], v16 offset:41984
  s_waitcnt lgkmcnt(9)
  v_mfma_f32_16x16x32_bf16 v[40:43], v[68:71], v[96:99], v[40:43]
  ds_read_b64_tr_b16 v[84:85], v17 offset:40960
  ds_read_b64_tr_b16 v[86:87], v17 offset:41984
  v_mfma_f32_16x16x32_bf16 v[44:47], v[68:71], v[100:103], v[44:47]
  ds_read_b64_tr_b16 v[88:89], v18 offset:40960
  ds_read_b64_tr_b16 v[90:91], v18 offset:41984
  s_waitcnt lgkmcnt(11)
  v_mfma_f32_16x16x32_bf16 v[48:51], v[72:75], v[96:99], v[48:51]
  ds_read_b64_tr_b16 v[92:93], v19 offset:40960
  ds_read_b64_tr_b16 v[94:95], v19 offset:41984
  ds_read_b32 v30, v28
  v_mfma_f32_16x16x32_bf16 v[52:55], v[72:75], v[100:103], v[52:55]
  s_waitcnt lgkmcnt(12)
  v_mfma_f32_16x16x32_bf16 v[56:59], v[76:79], v[96:99], v[56:59]
  v_mfma_f32_16x16x32_bf16 v[60:63], v[76:79], v[100:103], v[60:63]
  s_waitcnt lgkmcnt(0)
  v_readfirstlane_b32 s53, v30
  s_cmp_ge_u32 s53, 56
  s_cbranch_scc1 L1_ok6
L1_sp6:
  ds_read_b32 v30, v28
  s_waitcnt lgkmcnt(0)
  v_readfirstlane_b32 s53, v30
  s_cmp_ge_u32 s53, 56
  s_cbranch_scc1 L1_ok6
  s_sleep 1
  s_branch L1_sp6
L1_ok6:
  v_mfma_f32_16x16x32_bf16 v[32:35], v[80:83], v[104:107], v[32:35]
  ds_read_b128 v[96:99], v13 offset:0
  ds_read_b128 v[100:103], v13 offset:2048
  v_mfma_f32_16x16x32_bf16 v[36:39], v[80:83], v[108:111], v[36:39]
  ds_read_b64_tr_b16 v[64:65], v20 offset:0
  ds_read_b64_tr_b16 v[66:67], v20 offset:1024
  v_mfma_f32_16x16x32_bf16 v[40:43], v[84:87], v[104:107], v[40:43]
  ds_read_b64_tr_b16 v[68:69], v21 offset:0
  ds_read_b64_tr_b16 v[70:71], v21 offset:1024
  v_mfma_f32_16x16x32_bf16 v[44:47], v[84:87], v[108:111], v[44:47]
  ds_read_b64_tr_b16 v[72:73], v22 offset:0
  ds_read_b64_tr_b16 v[74:75], v22 offset:1024
  v_mfma_f32_16x16x32_bf16 v[48:51], v[88:91], v[104:107], v[48:51]
  ds_read_b64_tr_b16 v[76:77], v23 offset:0
  ds_read_b64_tr_b16 v[78:79], v23 offset:1024
  s_mov_b32 m0, s48
  s_add_u32 s49, s48, 1024
  buffer_load_dwordx4 v8, s[16:19], s47 offen lds
  v_mfma_f32_16x16x32_bf16 v[52:55], v[88:91], v[108:111], v[52:55]
  s_mov_b32 m0, s49
  s_add_u32 s49, s48, 16384
  buffer_load_dwordx4 v9, s[16:19], s47 offen lds
  v_mfma_f32_16x16x32_bf16 v[56:59], v[92:95], v[104:107], v[56:59]
  s_mov_b32 m0, s49
  s_add_u32 s49, s48, 17408
  buffer_load_dwordx4 v10, s[20:23], s46 offen lds
  v_mfma_f32_16x16x32_bf16 v[60:63], v[92:95], v[108:111], v[60:63]
  s_mov_b32 m0, s49
  s_add_u32 s50, s46, 4*3456
  buffer_load_dwordx4 v10, s[20:23], s50 offen lds
  s_add_u32 s46, s46, 64*3456
  s_add_u32 s47, s47, 128
  s_add_u32 s48, s48, 32768
  s_and_b32 s48, s48, 0x1ffff
  s_waitcnt vmcnt(4)
  s_mov_b64 exec, 1
  ds_add_u32 v28, v29
  s_mov_b64 exec, -1
  s_waitcnt lgkmcnt(7)
  v_mfma_f32_16x16x32_bf16 v[32:35], v[64:67], v[96:99], v[32:35]
  ds_read_b128 v[104:107], v14 offset:0
  ds_read_b128 v[108:111], v14 offset:2048
  v_mfma_f32_16x16x32_bf16 v[36:39], v[64:67], v[100:103], v[36:39]
  ds_read_b64_tr_b16 v[80:81], v20 offset:8192
  ds_read_b64_tr_b16 v[82:83], v20 offset:9216
  s_waitcnt lgkmcnt(9)
  v_mfma_f32_16x16x32_bf16 v[40:43], v[68:71], v[96:99], v[40:43]
  ds_read_b64_tr_b16 v[84:85], v21 offset:8192
  ds_read_b64_tr_b16 v[86:87], v21 offset:9216
  v_mfma_f32_16x16x32_bf16 v[44:47], v[68:71], v[100:103], v[44:47]
  ds_read_b64_tr_b16 v[88:89], v22 offset:8192
  ds_read_b64_tr_b16 v[90:91], v22 offset:9216
  s_waitcnt lgkmcnt(11)
  v_mfma_f32_16x16x32_bf16 v[48:51], v[72:75], v[96:99], v[48:51]
  ds_read_b64_tr_b16 v[92:93], v23 offset:8192
  ds_read_b64_tr_b16 v[94:95], v23 offset:9216
  ds_read_b32 v30, v28
  v_mfma_f32_16x16x32_bf16 v[52:55], v[72:75], v[100:103], v[52:55]
  s_waitcnt lgkmcnt(12)
  v_mfma_f32_16x16x32_bf16 v[56:59], v[76:79], v[96:99], v[56:59]
  v_mfma_f32_16x16x32_bf16 v[60:63], v[76:79], v[100:103], v[60:63]
  s_waitcnt lgkmcnt(0)
  v_readfirstlane_b32 s53, v30
  s_cmp_ge_u32 s53, 64
  s_cbranch_scc1 L1_ok7
L1_sp7:
  ds_read_b32 v30, v28
  s_waitcnt lgkmcnt(0)
  v_readfirstlane_b32 s53, v30
  s_cmp_ge_u32 s53, 64
  s_cbranch_scc1 L1_ok7
  s_sleep 1
  s_branch L1_sp7
L1_ok7:
  v_mfma_f32_16x16x32_bf16 v[32:35], v[80:83], v[104:107], v[32:35]
  ds_read_b128 v[96:99], v13 offset:32768
  ds_read_b128 v[100:103], v13 offset:34816
  v_mfma_f32_16x16x32_bf16 v[36:39], v[80:83], v[108:111], v[36:39]
  ds_read_b64_tr_b16 v[64:65], v20 offset:32768
  ds_read_b64_tr_b16 v[66:67], v20 offset:33792
  v_mfma_f32_16x16x32_bf16 v[40:43], v[84:87], v[104:107], v[40:43]
  ds_read_b64_tr_b16 v[68:69], v21 offset:32768
  ds_read_b64_tr_b16 v[70:71], v21 offset:33792
  v_mfma_f32_16x16x32_bf16 v[44:47], v[84:87], v[108:111], v[44:47]
  ds_read_b64_tr_b16 v[72:73], v22 offset:32768
  ds_read_b64_tr_b16 v[74:75], v22 offset:33792
  v_mfma_f32_16x16x32_bf16 v[48:51], v[88:91], v[104:107], v[48:51]
  ds_read_b64_tr_b16 v[76:77], v23 offset:32768
  ds_read_b64_tr_b16 v[78:79], v23 offset:33792
  v_mfma_f32_16x16x32_bf16 v[52:55], v[88:91], v[108:111], v[52:55]
  v_mfma_f32_16x16x32_bf16 v[56:59], v[92:95], v[104:107], v[56:59]
  v_mfma_f32_16x16x32_bf16 v[60:63], v[92:95], v[108:111], v[60:63]
  s_waitcnt vmcnt(0)
  s_mov_b64 exec, 1
  ds_add_u32 v28, v29
  s_mov_b64 exec, -1
  s_waitcnt lgkmcnt(7)
  v_mfma_f32_16x16x32_bf16 v[32:35], v[64:67], v[96:99], v[32:35]
  ds_read_b128 v[104:107], v14 offset:32768
  ds_read_b128 v[108:111], v14 offset:34816
  v_mfma_f32_16x16x32_bf16 v[36:39], v[64:67], v[100:103], v[36:39]
  ds_read_b64_tr_b16 v[80:81], v20 offset:40960
  ds_read_b64_tr_b16 v[82:83], v20 offset:41984
  s_waitcnt lgkmcnt(9)
  v_mfma_f32_16x16x32_bf16 v[40:43], v[68:71], v[96:99], v[40:43]
  ds_read_b64_tr_b16 v[84:85], v21 offset:40960
  ds_read_b64_tr_b16 v[86:87], v21 offset:41984
  v_mfma_f32_16x16x32_bf16 v[44:47], v[68:71], v[100:103], v[44:47]
  ds_read_b64_tr_b16 v[88:89], v22 offset:40960
  ds_read_b64_tr_b16 v[90:91], v22 offset:41984
  s_waitcnt lgkmcnt(11)
  v_mfma_f32_16x16x32_bf16 v[48:51], v[72:75], v[96:99], v[48:51]
  ds_read_b64_tr_b16 v[92:93], v23 offset:40960
  ds_read_b64_tr_b16 v[94:95], v23 offset:41984
  ds_read_b32 v30, v28
  v_mfma_f32_16x16x32_bf16 v[52:55], v[72:75], v[100:103], v[52:55]
  s_waitcnt lgkmcnt(12)
  v_mfma_f32_16x16x32_bf16 v[56:59], v[76:79], v[96:99], v[56:59]
  v_mfma_f32_16x16x32_bf16 v[60:63], v[76:79], v[100:103], v[60:63]
  s_waitcnt lgkmcnt(0)
  v_readfirstlane_b32 s53, v30
  s_cmp_ge_u32 s53, 72
  s_cbranch_scc1 L1_ok8
L1_sp8:
  ds_read_b32 v30, v28
  s_waitcnt lgkmcnt(0)
  v_readfirstlane_b32 s53, v30
  s_cmp_ge_u32 s53, 72
  s_cbranch_scc1 L1_ok8
  s_sleep 1
  s_branch L1_sp8
L1_ok8:
  v_mfma_f32_16x16x32_bf16 v[32:35], v[80:83], v[104:107], v[32:35]
  ds_read_b128 v[96:99], v11 offset:0
  ds_read_b128 v[100:103], v11 offset:2048
  v_mfma_f32_16x16x32_bf16 v[36:39], v[80:83], v[108:111], v[36:39]
  ds_read_b64_tr_b16 v[64:65], v16 offset:0
  ds_read_b64_tr_b16 v[66:67], v16 offset:1024
  v_mfma_f32_16x16x32_bf16 v[40:43], v[84:87], v[104:107], v[40:43]
  ds_read_b64_tr_b16 v[68:69], v17 offset:0
  ds_read_b64_tr_b16 v[70:71], v17 offset:1024
  v_mfma_f32_16x16x32_bf16 v[44:47], v[84:87], v[108:111], v[44:47]
  ds_read_b64_tr_b16 v[72:73], v18 offset:0
  ds_read_b64_tr_b16 v[74:75], v18 offset:1024
  v_mfma_f32_16x16x32_bf16 v[48:51], v[88:91], v[104:107], v[48:51]
  ds_read_b64_tr_b16 v[76:77], v19 offset:0
  ds_read_b64_tr_b16 v[78:79], v19 offset:1024
  v_mfma_f32_16x16x32_bf16 v[52:55], v[88:91], v[108:111], v[52:55]
  v_mfma_f32_16x16x32_bf16 v[56:59], v[92:95], v[104:107], v[56:59]
  v_mfma_f32_16x16x32_bf16 v[60:63], v[92:95], v[108:111], v[60:63]
  s_waitcnt lgkmcnt(6)
  v_mfma_f32_16x16x32_bf16 v[32:35], v[64:67], v[96:99], v[32:35]
  ds_read_b128 v[104:107], v12 offset:0
  ds_read_b128 v[108:111], v12 offset:2048
  v_mfma_f32_16x16x32_bf16 v[36:39], v[64:67], v[100:103], v[36:39]
  ds_read_b64_tr_b16 v[80:81], v16 offset:8192
  ds_read_b64_tr_b16 v[82:83], v16 offset:9216
  s_waitcnt lgkmcnt(8)
  v_mfma_f32_16x16x32_bf16 v[40:43], v[68:71], v[96:99], v[40:43]
  ds_read_b64_tr_b16 v[84:85], v17 offset:8192
  ds_read_b64_tr_b16 v[86:87], v17 offset:9216
  v_mfma_f32_16x16x32_bf16 v[44:47], v[68:71], v[100:103], v[44:47]
  ds_read_b64_tr_b16 v[88:89], v18 offset:8192
  ds_read_b64_tr_b16 v[90:91], v18 offset:9216
  s_waitcnt lgkmcnt(10)
  v_mfma_f32_16x16x32_bf16 v[48:51], v[72:75], v[96:99], v[48:51]
  ds_read_b64_tr_b16 v[92:93], v19 offset:8192
  ds_read_b64_tr_b16 v[94:95], v19 offset:9216
  v_mfma_f32_16x16x32_bf16 v[52:55], v[72:75], v[100:103], v[52:55]
  s_waitcnt lgkmcnt(10)
  v_mfma_f32_16x16x32_bf16 v[56:59], v[76:79], v[96:99], v[56:59]
  v_mfma_f32_16x16x32_bf16 v[60:63], v[76:79], v[100:103], v[60:63]
  s_waitcnt lgkmcnt(0)
  v_mfma_f32_16x16x32_bf16 v[32:35], v[80:83], v[104:107], v[32:35]
  v_mfma_f32_16x16x32_bf16 v[36:39], v[80:83], v[108:111], v[36:39]
  v_mfma_f32_16x16x32_bf16 v[40:43], v[84:87], v[104:107], v[40:43]
  v_mfma_f32_16x16x32_bf16 v[44:47], v[84:87], v[108:111], v[44:47]
  v_mfma_f32_16x16x32_bf16 v[48:51], v[88:91], v[104:107], v[48:51]
  v_mfma_f32_16x16x32_bf16 v[52:55], v[88:91], v[108:111], v[52:55]
  v_mfma_f32_16x16x32_bf16 v[56:59], v[92:95], v[104:107], v[56:59]
  v_mfma_f32_16x16x32_bf16 v[60:63], v[92:95], v[108:111], v[60:63]
  v_mov_b32 v1, 161320
  v_mov_b32 v5, 1
  s_mov_b64 exec, 1
  ds_add_u32 v1, v5
  s_mov_b64 exec, -1
  v_mul_f32 v32, v120, v32
  v_mul_f32 v33, v120, v33
  v_mul_f32 v36, v120, v36
  v_mul_f32 v37, v120, v37
  v_mul_f32 v34, v121, v34
  v_mul_f32 v35, v121, v35
  v_mul_f32 v38, v121, v38
  v_mul_f32 v39, v121, v39
  v_mul_f32 v40, v122, v40
  v_mul_f32 v41, v122, v41
  v_mul_f32 v44, v122, v44
  v_mul_f32 v45, v122, v45
  v_mul_f32 v42, v123, v42
  v_mul_f32 v43, v123, v43
  v_mul_f32 v46, v123, v46
  v_mul_f32 v47, v123, v47
  v_mul_f32 v48, v124, v48
  v_mul_f32 v49, v124, v49
  v_mul_f32 v52, v124, v52
  v_mul_f32 v53, v124, v53
  v_mul_f32 v50, v125, v50
  v_mul_f32 v51, v125, v51
  v_mul_f32 v54, v125, v54
  v_mul_f32 v55, v125, v55
  v_mul_f32 v56, v126, v56
  v_mul_f32 v57, v126, v57
  v_mul_f32 v60, v126, v60
  v_mul_f32 v61, v126, v61
  v_mul_f32 v58, v127, v58
  v_mul_f32 v59, v127, v59
  v_mul_f32 v62, v127, v62
  v_mul_f32 v63, v127, v63
  v_cvt_pk_bf16_f32 v32, v32, v33
  v_cvt_pk_bf16_f32 v36, v36, v37
  v_cvt_pk_bf16_f32 v34, v34, v35
  v_cvt_pk_bf16_f32 v38, v38, v39
  v_cvt_pk_bf16_f32 v40, v40, v41
  v_cvt_pk_bf16_f32 v44, v44, v45
  v_cvt_pk_bf16_f32 v42, v42, v43
  v_cvt_pk_bf16_f32 v46, v46, v47
  v_cvt_pk_bf16_f32 v48, v48, v49
  v_cvt_pk_bf16_f32 v52, v52, v53
  v_cvt_pk_bf16_f32 v50, v50, v51
  v_cvt_pk_bf16_f32 v54, v54, v55
  v_cvt_pk_bf16_f32 v56, v56, v57
  v_cvt_pk_bf16_f32 v60, v60, v61
  v_cvt_pk_bf16_f32 v58, v58, v59
  v_cvt_pk_bf16_f32 v62, v62, v63
  ds_write_b32 v112, v32 offset:0
  ds_write_b32 v112, v36 offset:4864
  ds_write_b32 v113, v34 offset:0
  ds_write_b32 v113, v38 offset:4864
  ds_write_b32 v114, v40 offset:0
  ds_write_b32 v114, v44 offset:4864
  ds_write_b32 v115, v42 offset:0
  ds_write_b32 v115, v46 offset:4864
  ds_write_b32 v116, v48 offset:0
  ds_write_b32 v116, v52 offset:4864
  ds_write_b32 v117, v50 offset:0
  ds_write_b32 v117, v54 offset:4864
  ds_write_b32 v118, v56 offset:0
  ds_write_b32 v118, v60 offset:4864
  ds_write_b32 v119, v58 offset:0
  ds_write_b32 v119, v62 offset:4864
  s_waitcnt lgkmcnt(0)
  s_branch L1_out
L1_side:
  s_sub_u32 s43, s42, 8
  s_cmp_lg_u32 s42, 8
  s_cbranch_scc1 L1_noflag
  v_lshlrev_b32 v1, 2, v2
  v_add_u32 v1, 161280, v1
  v_mov_b32 v5, 0
  v_mov_b32 v6, 2
  v_cmp_le_u32 vcc, 4, v2
  s_nop 1
  v_cndmask_b32 v5, v5, v6, vcc
  v_cmp_le_u32 vcc, 8, v2
  v_mov_b32 v6, 0
  s_nop 0
  v_cndmask_b32 v5, v5, v6, vcc
  s_mov_b32 exec_hi, 0
  ds_write_b32 v1, v5
  s_mov_b64 exec, -1
L1_noflag:
  s_waitcnt lgkmcnt(0)
  s_barrier
  s_cmp_eq_u32 s42, 11
  s_cbranch_scc0 L1_kv
  s_load_dwordx2 s[16:17], s[0:1], 88
  s_waitcnt lgkmcnt(0)
  s_mov_b32 s20, s16
  s_and_b32 s21, s17, 0xffff
  s_mov_b32 s22, 0x100
  s_mov_b32 s23, 0x20000
  s_cmp_lg_u32 s2, 0
  s_cbranch_scc1 L1_noinit
  v_lshlrev_b32 v1, 7, v2
  v_add_u32 v1, 0x14c4000, v1
  v_mov_b32 v5, 0
  buffer_store_dword v5, v1, s[36:39], 0 offen sc1
  v_add_u32 v1, 8192, v1
  buffer_store_dword v5, v1, s[36:39], 0 offen sc1
  v_add_u32 v1, 8192, v1
  buffer_store_dword v5, v1, s[36:39], 0 offen sc1
  v_add_u32 v1, 8192, v1
  buffer_store_dword v5, v1, s[36:39], 0 offen sc1
  v_add_u32 v1, 8192, v1
  s_waitcnt vmcnt(0)
  v_mov_b32 v1, 0
  v_mov_b32 v5, 1
  s_mov_b64 exec, 1
  buffer_store_dword v5, v1, s[20:23], 0 offen sc1
  s_mov_b64 exec, -1
L1_noinit:
  v_mov_b32 v28, 0
  s_mov_b32 s57, 200000
L1_ip:
  buffer_load_dword v7, v28, s[20:23], 0 offen sc1
  s_waitcnt vmcnt(0)
  v_readfirstlane_b32 s56, v7
  s_cmp_eq_u32 s56, 1
  s_cbranch_scc1 L1_ipx
  s_sleep 8
  s_sub_u32 s57, s57, 1
  s_cmp_lg_u32 s57, 0
  s_cbranch_scc1 L1_ip
L1_ipx:
  v_mov_b32 v1, 161344
  v_mov_b32 v7, 1
  ds_write_b32 v1, v7
  s_waitcnt lgkmcnt(0)
  s_and_b32 s40, s2, 31
  s_mul_i32 s43, s40, 147456
  v_lshlrev_b32 v3, 4, v2
  s_setprio 3
  v_mov_b32 v1, 161328
Lspin_1:
  ds_read_b32 v4, v1
  s_waitcnt lgkmcnt(0)
  v_readfirstlane_b32 s56, v4
  s_cmp_ge_u32 s56, 8
  s_cbranch_scc1 Lspin_1_x
  s_sleep 3
  s_branch Lspin_1
Lspin_1_x:
  v_and_b32 v5, 1, v2
  v_add_u32 v5, 1, v5
  v_lshlrev_b32 v5, 5, v5
  v_add_u32 v5, s40, v5
  v_mul_u32_u24 v5, 0x2aab, v5
  v_lshrrev_b32 v5, 16, v5
  v_lshlrev_b32 v5, 10, v5
  v_add_u32 v5, 0x14c4080, v5
  v_mov_b32 v6, 2
  s_add_u32 s43, s43, 18432
  v_add_u32 v4, 18432, v3
  s_mov_b32 s44, 1
L2_ldstage:
  s_mov_b32 s57, 200000
Lpoll_2:
  buffer_load_dword v7, v5, s[36:39], 0 offen sc1
  s_waitcnt vmcnt(0)
  v_cmp_lt_u32 vcc, v7, v6
  s_nop 3
  s_cmp_eq_u64 vcc, 0
  s_cbranch_scc1 Lpoll_2_x
  s_sleep 3
  s_sub_u32 s57, s57, 1
  s_cmp_lg_u32 s57, 0
  s_cbranch_scc1 Lpoll_2
Lpoll_2_x:
  buffer_load_dwordx4 v[8:11], v3, s[36:39], s43 offen offset:0 sc1
  buffer_load_dwordx4 v[12:15], v3, s[36:39], s43 offen offset:1024 sc1
  buffer_load_dwordx4 v[16:19], v3, s[36:39], s43 offen offset:2048 sc1
  buffer_load_dwordx4 v[20:23], v3, s[36:39], s43 offen offset:3072 sc1
  s_add_u32 s43, s43, 4096
  buffer_load_dwordx4 v[24:27], v3, s[36:39], s43 offen offset:0 sc1
  buffer_load_dwordx4 v[28:31], v3, s[36:39], s43 offen offset:1024 sc1
  buffer_load_dwordx4 v[32:35], v3, s[36:39], s43 offen offset:2048 sc1
  buffer_load_dwordx4 v[36:39], v3, s[36:39], s43 offen offset:3072 sc1
  s_add_u32 s43, s43, 4096
  buffer_load_dwordx4 v[40:43], v3, s[36:39], s43 offen offset:0 sc1
  buffer_load_dwordx4 v[44:47], v3, s[36:39], s43 offen offset:1024 sc1
  buffer_load_dwordx4 v[48:51], v3, s[36:39], s43 offen offset:2048 sc1
  buffer_load_dwordx4 v[52:55], v3, s[36:39], s43 offen offset:3072 sc1
  s_add_u32 s43, s43, 4096
  buffer_load_dwordx4 v[56:59], v3, s[36:39], s43 offen offset:0 sc1
  buffer_load_dwordx4 v[60:63], v3, s[36:39], s43 offen offset:1024 sc1
  buffer_load_dwordx4 v[64:67], v3, s[36:39], s43 offen offset:2048 sc1
  buffer_load_dwordx4 v[68:71], v3, s[36:39], s43 offen offset:3072 sc1
  s_add_u32 s43, s43, 4096
  buffer_load_dwordx4 v[72:75], v3, s[36:39], s43 offen offset:0 sc1
  buffer_load_dwordx4 v[76:79], v3, s[36:39], s43 offen offset:1024 sc1
  s_add_u32 s43, s43, 2048
  s_waitcnt vmcnt(17)
  ds_write_b128 v4, v[8:11] offset:0
  s_waitcnt vmcnt(16)
  ds_write_b128 v4, v[12:15] offset:1024
  s_waitcnt vmcnt(15)
  ds_write_b128 v4, v[16:19] offset:2048
  s_waitcnt vmcnt(14)
  ds_write_b128 v4, v[20:23] offset:3072
  s_waitcnt vmcnt(13)
  ds_write_b128 v4, v[24:27] offset:4096
  s_waitcnt vmcnt(12)
  ds_write_b128 v4, v[28:31] offset:5120
  s_waitcnt vmcnt(11)
  ds_write_b128 v4, v[32:35] offset:6144
  s_waitcnt vmcnt(10)
  ds_write_b128 v4, v[36:39] offset:7168
  s_waitcnt vmcnt(9)
  ds_write_b128 v4, v[40:43] offset:8192
  s_waitcnt vmcnt(8)
  ds_write_b128 v4, v[44:47] offset:9216
  s_waitcnt vmcnt(7)
  ds_write_b128 v4, v[48:51] offset:10240
  s_waitcnt vmcnt(6)
  ds_write_b128 v4, v[52:55] offset:11264
  s_waitcnt vmcnt(5)
  ds_write_b128 v4, v[56:59] offset:12288
  s_waitcnt vmcnt(4)
  ds_write_b128 v4, v[60:63] offset:13312
  s_waitcnt vmcnt(3)
  ds_write_b128 v4, v[64:67] offset:14336
  s_waitcnt vmcnt(2)
  ds_write_b128 v4, v[68:71] offset:15360
  s_waitcnt vmcnt(1)
  ds_write_b128 v4, v[72:75] offset:16384
  s_waitcnt vmcnt(0)
  ds_write_b128 v4, v[76:79] offset:17408
  v_add_u32 v4, 18432, v4
  v_add_u32 v5, 128, v5
  s_add_u32 s44, s44, 1
  s_waitcnt lgkmcnt(0)
  v_mov_b32 v1, 161284
  v_mov_b32 v7, s44
  ds_write_b32 v1, v7
  s_cmp_lt_u32 s44, 8
  s_cbranch_scc1 L2_ldstage
  s_waitcnt lgkmcnt(0)
  s_setprio 1
  s_load_dwordx2 s[4:5], s[0:1], 0
  s_load_dwordx2 s[16:17], s[0:1], 16
  s_load_dwordx2 s[18:19], s[0:1], 72
  s_waitcnt lgkmcnt(0)
  s_mov_b32 s24, s4
  s_and_b32 s25, s5, 0xffff
  s_mov_b32 s26, 0x240000
  s_mov_b32 s27, 0x20000
  s_mov_b32 s28, s18
  s_and_b32 s29, s19, 0xffff
  s_mov_b32 s30, 0x480
  s_mov_b32 s31, 0x20000
  s_mov_b32 s32, s16
  s_and_b32 s33, s17, 0xffff
  s_mov_b32 s34, 0xa2000
  s_mov_b32 s35, 0x20000
  v_and_b32 v3, 15, v2
  v_lshrrev_b32 v4, 4, v2
  v_lshrrev_b32 v5, 3, v2
  v_and_b32 v6, 7, v2
  s_lshl_b32 s45, s2, 3
  v_add_u32 v9, s45, v5
  v_mul_u32_u24 v7, 1152, v9
  v_lshlrev_b32 v8, 4, v6
  v_add_u32 v7, v7, v8
  v_mul_u32_u24 v120, 8*1152, v4
  v_lshl_add_u32 v120, v3, 1, v120
  v_add_u32 v121, 4608, v120
  v_lshlrev_b32 v122, 4, v2
  buffer_load_dwordx4 v[12:15], v7, s[24:27], 0 offen offset:0
  buffer_load_dwordx4 v[48:51], v8, s[28:31], 0 offen offset:0
  buffer_load_dwordx4 v[16:19], v7, s[24:27], 0 offen offset:128
  buffer_load_dwordx4 v[52:55], v8, s[28:31], 0 offen offset:128
  buffer_load_dwordx4 v[20:23], v7, s[24:27], 0 offen offset:256
  buffer_load_dwordx4 v[56:59], v8, s[28:31], 0 offen offset:256
  buffer_load_dwordx4 v[24:27], v7, s[24:27], 0 offen offset:384
  buffer_load_dwordx4 v[60:63], v8, s[28:31], 0 offen offset:384
  buffer_load_dwordx4 v[28:31], v7, s[24:27], 0 offen offset:512
  buffer_load_dwordx4 v[64:67], v8, s[28:31], 0 offen offset:512
  buffer_load_dwordx4 v[32:35], v7, s[24:27], 0 offen offset:640
  buffer_load_dwordx4 v[68:71], v8, s[28:31], 0 offen offset:640
  buffer_load_dwordx4 v[36:39], v7, s[24:27], 0 offen offset:768
  buffer_load_dwordx4 v[72:75], v8, s[28:31], 0 offen offset:768
  buffer_load_dwordx4 v[40:43], v7, s[24:27], 0 offen offset:896
  buffer_load_dwordx4 v[76:79], v8, s[28:31], 0 offen offset:896
  buffer_load_dwordx4 v[44:47], v7, s[24:27], 0 offen offset:1024
  buffer_load_dwordx4 v[80:83], v8, s[28:31], 0 offen offset:1024
  s_add_u32 s45, s2, 0
  s_mul_hi_u32 s46, s45, 0xe38e38f
  s_mul_i32 s47, s46, 18
  s_sub_u32 s47, s45, s47
  s_mul_i32 s47, s47, 32*1152
  s_lshl_b32 s46, s46, 5
  s_add_u32 s47, s47, s46
  s_cmp_lt_u32 s45, 648
  s_cselect_b32 s47, s47, 0
  buffer_load_ushort v92, v120, s[32:35], s47 offen offset:0
  buffer_load_ushort v93, v120, s[32:35], s47 offen offset:1152
  buffer_load_ushort v94, v120, s[32:35], s47 offen offset:2304
  buffer_load_ushort v95, v120, s[32:35], s47 offen offset:3456
  buffer_load_ushort v96, v121, s[32:35], s47 offen offset:0
  buffer_load_ushort v97, v121, s[32:35], s47 offen offset:1152
  buffer_load_ushort v98, v121, s[32:35], s47 offen offset:2304
  buffer_load_ushort v99, v121, s[32:35], s47 offen offset:3456
  s_add_u32 s45, s2, 256
  s_mul_hi_u32 s46, s45, 0xe38e38f
  s_mul_i32 s47, s46, 18
  s_sub_u32 s47, s45, s47
  s_mul_i32 s47, s47, 32*1152
  s_lshl_b32 s46, s46, 5
  s_add_u32 s47, s47, s46
  s_cmp_lt_u32 s45, 648
  s_cselect_b32 s47, s47, 0
  buffer_load_ushort v100, v120, s[32:35], s47 offen offset:0
  buffer_load_ushort v101, v120, s[32:35], s47 offen offset:1152
  buffer_load_ushort v102, v120, s[32:35], s47 offen offset:2304
  buffer_load_ushort v103, v120, s[32:35], s47 offen offset:3456
  buffer_load_ushort v104, v121, s[32:35], s47 offen offset:0
  buffer_load_ushort v105, v121, s[32:35], s47 offen offset:1152
  buffer_load_ushort v106, v121, s[32:35], s47 offen offset:2304
  buffer_load_ushort v107, v121, s[32:35], s47 offen offset:3456
  s_add_u32 s45, s2, 512
  s_mul_hi_u32 s46, s45, 0xe38e38f
  s_mul_i32 s47, s46, 18
  s_sub_u32 s47, s45, s47
  s_mul_i32 s47, s47, 32*1152
  s_lshl_b32 s46, s46, 5
  s_add_u32 s47, s47, s46
  s_cmp_lt_u32 s45, 648
  s_cselect_b32 s47, s47, 0
  buffer_load_ushort v108, v120, s[32:35], s47 offen offset:0
  buffer_load_ushort v109, v120, s[32:35], s47 offen offset:1152
  buffer_load_ushort v110, v120, s[32:35], s47 offen offset:2304
  buffer_load_ushort v111, v120, s[32:35], s47 offen offset:3456
  buffer_load_ushort v112, v121, s[32:35], s47 offen offset:0
  buffer_load_ushort v113, v121, s[32:35], s47 offen offset:1152
  buffer_load_ushort v114, v121, s[32:35], s47 offen offset:2304
  buffer_load_ushort v115, v121, s[32:35], s47 offen offset:3456
  s_waitcnt vmcnt(0)
  v_mov_b32 v84, 0
  v_dot2_f32_bf16 v84, v12, v48, v84
  v_dot2_f32_bf16 v84, v13, v49, v84
  v_dot2_f32_bf16 v84, v14, v50, v84
  v_dot2_f32_bf16 v84, v15, v51, v84
  v_dot2_f32_bf16 v84, v16, v52, v84
  v_dot2_f32_bf16 v84, v17, v53, v84
  v_dot2_f32_bf16 v84, v18, v54, v84
  v_dot2_f32_bf16 v84, v19, v55, v84
  v_dot2_f32_bf16 v84, v20, v56, v84
  v_dot2_f32_bf16 v84, v21, v57, v84
  v_dot2_f32_bf16 v84, v22, v58, v84
  v_dot2_f32_bf16 v84, v23, v59, v84
  v_dot2_f32_bf16 v84, v24, v60, v84
  v_dot2_f32_bf16 v84, v25, v61, v84
  v_dot2_f32_bf16 v84, v26, v62, v84
  v_dot2_f32_bf16 v84, v27, v63, v84
  v_dot2_f32_bf16 v84, v28, v64, v84
  v_dot2_f32_bf16 v84, v29, v65, v84
  v_dot2_f32_bf16 v84, v30, v66, v84
  v_dot2_f32_bf16 v84, v31, v67, v84
  v_dot2_f32_bf16 v84, v32, v68, v84
  v_dot2_f32_bf16 v84, v33, v69, v84
  v_dot2_f32_bf16 v84, v34, v70, v84
  v_dot2_f32_bf16 v84, v35, v71, v84
  v_dot2_f32_bf16 v84, v36, v72, v84
  v_dot2_f32_bf16 v84, v37, v73, v84
  v_dot2_f32_bf16 v84, v38, v74, v84
  v_dot2_f32_bf16 v84, v39, v75, v84
  v_dot2_f32_bf16 v84, v40, v76, v84
  v_dot2_f32_bf16 v84, v41, v77, v84
  v_dot2_f32_bf16 v84, v42, v78, v84
  v_dot2_f32_bf16 v84, v43, v79, v84
  v_dot2_f32_bf16 v84, v44, v80, v84
  v_dot2_f32_bf16 v84, v45, v81, v84
  v_dot2_f32_bf16 v84, v46, v82, v84
  v_dot2_f32_bf16 v84, v47, v83, v84
  s_nop 3
  s_nop 1
  v_mov_b32_dpp v85, v84 quad_perm:[1,0,3,2] row_mask:0xf bank_mask:0xf
  s_nop 1
  v_add_f32 v84, v84, v85
  s_nop 1
  v_mov_b32_dpp v85, v84 quad_perm:[2,3,0,1] row_mask:0xf bank_mask:0xf
  s_nop 1
  v_add_f32 v84, v84, v85
  s_nop 1
  v_mov_b32_dpp v85, v84 row_half_mirror row_mask:0xf bank_mask:0xf
  s_nop 1
  v_add_f32 v84, v84, v85
  v_mul_f32 v84, 0xbfb8aa3b, v84
  v_exp_f32 v84, v84
  s_nop 0
  v_add_f32 v84, 1.0, v84
  v_rcp_f32 v84, v84
  v_lshlrev_b32 v85, 2, v9
  v_mov_b32 v86, 0x80000000
  v_cmp_eq_u32 vcc, 0, v6
  s_mov_b32 s46, 0x1320000
  s_nop 0
  v_cndmask_b32 v85, v86, v85, vcc
  buffer_store_dword v84, v85, s[36:39], s46 offen sc1
  v_lshl_or_b32 v124, v93, 16, v92
  v_lshl_or_b32 v125, v95, 16, v94
  v_lshl_or_b32 v126, v97, 16, v96
  v_lshl_or_b32 v127, v99, 16, v98
  s_add_u32 s45, s2, 0
  s_lshl_b32 s46, s45, 10
  s_add_u32 s46, s46, 0x1322000
  s_cmp_lt_u32 s45, 648
  s_cbranch_scc0 L1_nw0
  buffer_store_dwordx4 v[124:127], v122, s[36:39], s46 offen sc1
L1_nw0:
  v_lshl_or_b32 v128, v101, 16, v100
  v_lshl_or_b32 v129, v103, 16, v102
  v_lshl_or_b32 v130, v105, 16, v104
  v_lshl_or_b32 v131, v107, 16, v106
  s_add_u32 s45, s2, 256
  s_lshl_b32 s46, s45, 10
  s_add_u32 s46, s46, 0x1322000
  s_cmp_lt_u32 s45, 648
  s_cbranch_scc0 L1_nw1
  buffer_store_dwordx4 v[128:131], v122, s[36:39], s46 offen sc1
L1_nw1:
  v_lshl_or_b32 v132, v109, 16, v108
  v_lshl_or_b32 v133, v111, 16, v110
  v_lshl_or_b32 v134, v113, 16, v112
  v_lshl_or_b32 v135, v115, 16, v114
  s_add_u32 s45, s2, 512
  s_lshl_b32 s46, s45, 10
  s_add_u32 s46, s46, 0x1322000
  s_cmp_lt_u32 s45, 648
  s_cbranch_scc0 L1_nw2
  buffer_store_dwordx4 v[132:135], v122, s[36:39], s46 offen sc1
L1_nw2:
  s_waitcnt vmcnt(0)
  s_mov_b32 s45, 144
  s_lshl_b32 s57, s45, 7
  s_add_u32 s57, s57, 0x14c4000
  v_mov_b32 v1, s57
  v_mov_b32 v4, 1
  s_mov_b64 exec, 1
  buffer_atomic_add v4, v1, s[36:39], 0 offen sc1
  s_mov_b64 exec, -1
  s_branch L_fin
L1_kv:
  v_mov_b32 v1, 161280
Lspin_3:
  ds_read_b32 v7, v1
  s_waitcnt lgkmcnt(0)
  v_readfirstlane_b32 s56, v7
  s_cmp_ge_u32 s56, 8
  s_cbranch_scc1 Lspin_3_x
  s_sleep 6
  s_branch Lspin_3
Lspin_3_x:
  s_setprio 3
  s_mov_b32 s24, s8
  s_and_b32 s25, s9, 0xffff
  s_mov_b32 s26, 0x240000
  s_mov_b32 s27, 0x20000
  s_mov_b32 s28, s10
  s_and_b32 s29, s11, 0xffff
  s_mov_b32 s30, 0x240000
  s_mov_b32 s31, 0x20000
  s_mov_b32 s32, s12
  s_and_b32 s33, s13, 0xffff
  s_mov_b32 s34, 0x1200
  s_mov_b32 s35, 0x20000
  s_mul_hi_u32 s44, s2, 0x15555556
  s_mul_i32 s45, s44, 12
  s_sub_u32 s45, s2, s45
  s_lshl_b32 s46, s43, 6
  v_add_u32 v8, s46, v2
  s_movk_i32 s46, 5462
  v_mul_u32_u24 v9, s46, v8
  v_lshrrev_b32 v9, 16, v9
  v_mul_u32_u24 v10, 12, v9
  v_sub_u32 v10, v8, v10
  s_lshl_b32 s46, s44, 7
  v_lshl_add_u32 v11, v9, 3, s46
  s_mul_i32 s46, s45, 96
  v_lshl_add_u32 v12, v10, 3, s46
  s_movk_i32 s46, 1152
  v_mul_lo_u32 v13, v11, s46
  v_add_u32 v13, v13, v12
  v_subrev_u32 v14, 3456, v13
  v_mov_b32 v15, 0x80000000
  v_cmp_eq_u32 vcc, 0, v11
  s_mul_i32 s46, s45, 384
  v_lshl_add_u32 v16, v10, 5, s46
  v_cndmask_b32 v14, v14, v15, vcc
  s_mul_i32 s46, s45, 48
  v_lshl_add_u32 v17, v10, 2, s46
  v_lshlrev_b32 v17, 12, v17
  v_sub_u32 v18, 15, v9
  v_lshl_add_u32 v17, v18, 4, v17
  s_lshl_b32 s47, s44, 8
  s_sub_u32 s47, 3840, s47
  s_add_u32 s47, s47, 0x6c0000
  s_cmp_lt_u32 s2, 192
  s_cbranch_scc1 L1_kvact
  v_mov_b32 v13, v15
  v_mov_b32 v14, v15
  v_mov_b32 v16, v15
  v_mov_b32 v17, v15
  s_mov_b32 s47, 0
L1_kvact:
  s_movk_i32 s48, 4608
  buffer_load_dwordx2 v[32:33], v14, s[24:27], 0 offen offset:0
  buffer_load_dwordx2 v[34:35], v14, s[24:27], 0 offen offset:1152
  buffer_load_dwordx2 v[36:37], v14, s[24:27], 0 offen offset:2304
  buffer_load_dwordx2 v[38:39], v13, s[24:27], 0 offen offset:0
  buffer_load_dwordx2 v[40:41], v13, s[24:27], 0 offen offset:1152
  buffer_load_dwordx2 v[42:43], v13, s[24:27], 0 offen offset:2304
  buffer_load_dwordx2 v[44:45], v13, s[24:27], 0 offen offset:3456
  buffer_load_dwordx2 v[46:47], v13, s[24:27], s48 offen offset:0
  buffer_load_dwordx2 v[48:49], v13, s[24:27], s48 offen offset:1152
  buffer_load_dwordx2 v[50:51], v13, s[24:27], s48 offen offset:2304
  buffer_load_dwordx2 v[52:53], v13, s[24:27], s48 offen offset:3456
  buffer_load_dwordx4 v[70:73], v16, s[32:35], 0 offen
  buffer_load_dwordx4 v[74:77], v16, s[32:35], 0 offen offset:16
  buffer_load_dwordx2 v[54:55], v13, s[28:31], 0 offen offset:0
  buffer_load_dwordx2 v[56:57], v13, s[28:31], 0 offen offset:1152
  buffer_load_dwordx2 v[58:59], v13, s[28:31], 0 offen offset:2304
  buffer_load_dwordx2 v[60:61], v13, s[28:31], 0 offen offset:3456
  buffer_load_dwordx2 v[62:63], v13, s[28:31], s48 offen offset:0
  buffer_load_dwordx2 v[64:65], v13, s[28:31], s48 offen offset:1152
  buffer_load_dwordx2 v[66:67], v13, s[28:31], s48 offen offset:2304
  buffer_load_dwordx2 v[68:69], v13, s[28:31], s48 offen offset:3456
  s_lshl_b32 s61, s43, 8
  s_add_u32 s61, s61, s2
  s_cmp_eq_u32 s43, 2
  s_cbranch_scc0 Lch_5
  s_add_u32 s61, s2, 320
  s_cmp_lt_u32 s2, 192
  s_cselect_b32 s61, 0xffff, s61
Lch_5:
  s_cmp_ge_u32 s61, 576
  s_cselect_b32 s58, 1, 0
  s_cmp_eq_u32 s42, 11
  s_cselect_b32 s58, 1, s58
  s_load_dwordx2 s[62:63], s[0:1], 56
  v_lshlrev_b32 v118, 4, v2
  v_subrev_u32 v119, 32, v118
  s_waitcnt lgkmcnt(0)
  s_min_u32 s61, s61, 575
  s_lshl_b32 s56, s61, 12
  s_add_u32 s64, s62, s56
  s_addc_u32 s65, s63, 0
  s_and_b32 s65, s65, 0xffff
  s_mov_b32 s66, 4096
  s_mov_b32 s67, 0x20000
  s_cmp_eq_u32 s58, 1
  s_cbranch_scc1 Lh_4
  buffer_load_dwordx4 v[120:123], v119, s[64:67], 0 offen
  v_add_u32 v117, 16, v119
  buffer_load_dword v124, v117, s[64:67], 0 offen
  v_add_u32 v117, 1024, v119
  buffer_load_dwordx4 v[128:131], v117, s[64:67], 0 offen
  buffer_load_dword v132, v117, s[64:67], 0 offen offset:16
  v_add_u32 v117, 2048, v119
  buffer_load_dwordx4 v[136:139], v117, s[64:67], 0 offen
  buffer_load_dword v140, v117, s[64:67], 0 offen offset:16
  v_add_u32 v117, 3072, v119
  buffer_load_dwordx4 v[144:147], v117, s[64:67], 0 offen
  buffer_load_dword v148, v117, s[64:67], 0 offen offset:16
  v_add_u32 v117, 4096, v119
  buffer_load_dwordx4 v[152:155], v117, s[64:67], 0 offen
  buffer_load_dword v156, v117, s[64:67], 0 offen offset:16
Lh_4:
  s_waitcnt vmcnt(0)
  s_cmp_eq_u32 s58, 1
  s_cbranch_scc1 Lhs_6
  s_mul_i32 s62, s61, 10240
  s_add_u32 s62, s62, 0x900000
  s_add_u32 s63, s62, 5120
  v_alignbit_b32 v160, v121, v120, 16
  v_alignbit_b32 v161, v122, v121, 16
  v_alignbit_b32 v162, v123, v122, 16
  v_alignbit_b32 v163, v124, v123, 16
  buffer_store_dwordx4 v[120:123], v118, s[36:39], s62 offen offset:0 nt
  buffer_store_dwordx4 v[160:163], v118, s[36:39], s63 offen offset:0 nt
  s_nop 1
  v_alignbit_b32 v164, v129, v128, 16
  v_alignbit_b32 v165, v130, v129, 16
  v_alignbit_b32 v166, v131, v130, 16
  v_alignbit_b32 v167, v132, v131, 16
  buffer_store_dwordx4 v[128:131], v118, s[36:39], s62 offen offset:1024 nt
  buffer_store_dwordx4 v[164:167], v118, s[36:39], s63 offen offset:1024 nt
  s_nop 1
  v_alignbit_b32 v160, v137, v136, 16
  v_alignbit_b32 v161, v138, v137, 16
  v_alignbit_b32 v162, v139, v138, 16
  v_alignbit_b32 v163, v140, v139, 16
  buffer_store_dwordx4 v[136:139], v118, s[36:39], s62 offen offset:2048 nt
  buffer_store_dwordx4 v[160:163], v118, s[36:39], s63 offen offset:2048 nt
  s_nop 1
  v_alignbit_b32 v164, v145, v144, 16
  v_alignbit_b32 v165, v146, v145, 16
  v_alignbit_b32 v166, v147, v146, 16
  v_alignbit_b32 v167, v148, v147, 16
  buffer_store_dwordx4 v[144:147], v118, s[36:39], s62 offen offset:3072 nt
  buffer_store_dwordx4 v[164:167], v118, s[36:39], s63 offen offset:3072 nt
  s_nop 1
  v_alignbit_b32 v160, v153, v152, 16
  v_alignbit_b32 v161, v154, v153, 16
  v_alignbit_b32 v162, v155, v154, 16
  v_alignbit_b32 v163, v156, v155, 16
  s_add_u32 s56, s62, 4096
  buffer_store_dwordx4 v[152:155], v118, s[36:39], s56 offen nt
  s_add_u32 s56, s63, 4096
  buffer_store_dwordx4 v[160:163], v118, s[36:39], s56 offen nt
  s_nop 1
Lhs_6:
  v_lshlrev_b32 v80, 16, v70
  v_and_b32 v81, 0xffff0000, v70
  v_lshlrev_b32 v82, 16, v71
  v_and_b32 v83, 0xffff0000, v71
  v_lshlrev_b32 v84, 16, v72
  v_and_b32 v85, 0xffff0000, v72
  v_lshlrev_b32 v86, 16, v73
  v_and_b32 v87, 0xffff0000, v73
  v_lshlrev_b32 v88, 16, v74
  v_and_b32 v89, 0xffff0000, v74
  v_lshlrev_b32 v90, 16, v75
  v_and_b32 v91, 0xffff0000, v75
  v_lshlrev_b32 v92, 16, v76
  v_and_b32 v93, 0xffff0000, v76
  v_lshlrev_b32 v94, 16, v77
  v_and_b32 v95, 0xffff0000, v77
  v_lshlrev_b32 v96, 16, v32
  v_lshlrev_b32 v97, 16, v34
  v_lshlrev_b32 v98, 16, v36
  v_lshlrev_b32 v99, 16, v38
  v_lshlrev_b32 v100, 16, v40
  v_lshlrev_b32 v101, 16, v42
  v_lshlrev_b32 v102, 16, v44
  v_lshlrev_b32 v103, 16, v46
  v_lshlrev_b32 v104, 16, v48
  v_lshlrev_b32 v105, 16, v50
  v_lshlrev_b32 v106, 16, v52
  v_mul_f32 v108, v96, v83
  v_mul_f32 v109, v97, v83
  v_mul_f32 v110, v98, v83
  v_mul_f32 v111, v99, v83
  v_mul_f32 v112, v100, v83
  v_mul_f32 v113, v101, v83
  v_mul_f32 v114, v102, v83
  v_mul_f32 v115, v103, v83
  v_fmac_f32 v108, v97, v82
  v_fmac_f32 v109, v98, v82
  v_fmac_f32 v110, v99, v82
  v_fmac_f32 v111, v100, v82
  v_fmac_f32 v112, v101, v82
  v_fmac_f32 v113, v102, v82
  v_fmac_f32 v114, v103, v82
  v_fmac_f32 v115, v104, v82
  v_fmac_f32 v108, v98, v81
  v_fmac_f32 v109, v99, v81
  v_fmac_f32 v110, v100, v81
  v_fmac_f32 v111, v101, v81
  v_fmac_f32 v112, v102, v81
  v_fmac_f32 v113, v103, v81
  v_fmac_f32 v114, v104, v81
  v_fmac_f32 v115, v105, v81
  v_fmac_f32 v108, v99, v80
  v_fmac_f32 v109, v100, v80
  v_fmac_f32 v110, v101, v80
  v_fmac_f32 v111, v102, v80
  v_fmac_f32 v112, v103, v80
  v_fmac_f32 v113, v104, v80
  v_fmac_f32 v114, v105, v80
  v_fmac_f32 v115, v106, v80
  v_lshlrev_b32 v96, 16, v54
  v_lshlrev_b32 v97, 16, v56
  v_lshlrev_b32 v98, 16, v58
  v_lshlrev_b32 v99, 16, v60
  v_lshlrev_b32 v100, 16, v62
  v_lshlrev_b32 v101, 16, v64
  v_lshlrev_b32 v102, 16, v66
  v_lshlrev_b32 v103, 16, v68
  v_mul_f32 v108, v108, v96
  v_mul_f32 v109, v109, v97
  v_mul_f32 v110, v110, v98
  v_mul_f32 v111, v111, v99
  v_mul_f32 v112, v112, v100
  v_mul_f32 v113, v113, v101
  v_mul_f32 v114, v114, v102
  v_mul_f32 v115, v115, v103
  v_cvt_pk_bf16_f32 v140, v115, v114
  v_cvt_pk_bf16_f32 v141, v113, v112
  v_cvt_pk_bf16_f32 v142, v111, v110
  v_cvt_pk_bf16_f32 v143, v109, v108
  s_add_u32 s46, s47, 0
  buffer_store_dwordx4 v[140:143], v17, s[36:39], s46 offen sc1
  v_and_b32 v96, 0xffff0000, v32
  v_and_b32 v97, 0xffff0000, v34
  v_and_b32 v98, 0xffff0000, v36
  v_and_b32 v99, 0xffff0000, v38
  v_and_b32 v100, 0xffff0000, v40
  v_and_b32 v101, 0xffff0000, v42
  v_and_b32 v102, 0xffff0000, v44
  v_and_b32 v103, 0xffff0000, v46
  v_and_b32 v104, 0xffff0000, v48
  v_and_b32 v105, 0xffff0000, v50
  v_and_b32 v106, 0xffff0000, v52
  v_mul_f32 v108, v96, v87
  v_mul_f32 v109, v97, v87
  v_mul_f32 v110, v98, v87
  v_mul_f32 v111, v99, v87
  v_mul_f32 v112, v100, v87
  v_mul_f32 v113, v101, v87
  v_mul_f32 v114, v102, v87
  v_mul_f32 v115, v103, v87
  v_fmac_f32 v108, v97, v86
  v_fmac_f32 v109, v98, v86
  v_fmac_f32 v110, v99, v86
  v_fmac_f32 v111, v100, v86
  v_fmac_f32 v112, v101, v86
  v_fmac_f32 v113, v102, v86
  v_fmac_f32 v114, v103, v86
  v_fmac_f32 v115, v104, v86
  v_fmac_f32 v108, v98, v85
  v_fmac_f32 v109, v99, v85
  v_fmac_f32 v110, v100, v85
  v_fmac_f32 v111, v101, v85
  v_fmac_f32 v112, v102, v85
  v_fmac_f32 v113, v103, v85
  v_fmac_f32 v114, v104, v85
  v_fmac_f32 v115, v105, v85
  v_fmac_f32 v108, v99, v84
  v_fmac_f32 v109, v100, v84
  v_fmac_f32 v110, v101, v84
  v_fmac_f32 v111, v102, v84
  v_fmac_f32 v112, v103, v84
  v_fmac_f32 v113, v104, v84
  v_fmac_f32 v114, v105, v84
  v_fmac_f32 v115, v106, v84
  v_and_b32 v96, 0xffff0000, v54
  v_and_b32 v97, 0xffff0000, v56
  v_and_b32 v98, 0xffff0000, v58
  v_and_b32 v99, 0xffff0000, v60
  v_and_b32 v100, 0xffff0000, v62
  v_and_b32 v101, 0xffff0000, v64
  v_and_b32 v102, 0xffff0000, v66
  v_and_b32 v103, 0xffff0000, v68
  v_mul_f32 v108, v108, v96
  v_mul_f32 v109, v109, v97
  v_mul_f32 v110, v110, v98
  v_mul_f32 v111, v111, v99
  v_mul_f32 v112, v112, v100
  v_mul_f32 v113, v113, v101
  v_mul_f32 v114, v114, v102
  v_mul_f32 v115, v115, v103
  v_cvt_pk_bf16_f32 v144, v115, v114
  v_cvt_pk_bf16_f32 v145, v113, v112
  v_cvt_pk_bf16_f32 v146, v111, v110
  v_cvt_pk_bf16_f32 v147, v109, v108
  s_add_u32 s46, s47, 4096
  buffer_store_dwordx4 v[144:147], v17, s[36:39], s46 offen sc1
  v_lshlrev_b32 v96, 16, v33
  v_lshlrev_b32 v97, 16, v35
  v_lshlrev_b32 v98, 16, v37
  v_lshlrev_b32 v99, 16, v39
  v_lshlrev_b32 v100, 16, v41
  v_lshlrev_b32 v101, 16, v43
  v_lshlrev_b32 v102, 16, v45
  v_lshlrev_b32 v103, 16, v47
  v_lshlrev_b32 v104, 16, v49
  v_lshlrev_b32 v105, 16, v51
  v_lshlrev_b32 v106, 16, v53
  v_mul_f32 v108, v96, v91
  v_mul_f32 v109, v97, v91
  v_mul_f32 v110, v98, v91
  v_mul_f32 v111, v99, v91
  v_mul_f32 v112, v100, v91
  v_mul_f32 v113, v101, v91
  v_mul_f32 v114, v102, v91
  v_mul_f32 v115, v103, v91
  v_fmac_f32 v108, v97, v90
  v_fmac_f32 v109, v98, v90
  v_fmac_f32 v110, v99, v90
  v_fmac_f32 v111, v100, v90
  v_fmac_f32 v112, v101, v90
  v_fmac_f32 v113, v102, v90
  v_fmac_f32 v114, v103, v90
  v_fmac_f32 v115, v104, v90
  v_fmac_f32 v108, v98, v89
  v_fmac_f32 v109, v99, v89
  v_fmac_f32 v110, v100, v89
  v_fmac_f32 v111, v101, v89
  v_fmac_f32 v112, v102, v89
  v_fmac_f32 v113, v103, v89
  v_fmac_f32 v114, v104, v89
  v_fmac_f32 v115, v105, v89
  v_fmac_f32 v108, v99, v88
  v_fmac_f32 v109, v100, v88
  v_fmac_f32 v110, v101, v88
  v_fmac_f32 v111, v102, v88
  v_fmac_f32 v112, v103, v88
  v_fmac_f32 v113, v104, v88
  v_fmac_f32 v114, v105, v88
  v_fmac_f32 v115, v106, v88
  v_lshlrev_b32 v96, 16, v55
  v_lshlrev_b32 v97, 16, v57
  v_lshlrev_b32 v98, 16, v59
  v_lshlrev_b32 v99, 16, v61
  v_lshlrev_b32 v100, 16, v63
  v_lshlrev_b32 v101, 16, v65
  v_lshlrev_b32 v102, 16, v67
  v_lshlrev_b32 v103, 16, v69
  v_mul_f32 v108, v108, v96
  v_mul_f32 v109, v109, v97
  v_mul_f32 v110, v110, v98
  v_mul_f32 v111, v111, v99
  v_mul_f32 v112, v112, v100
  v_mul_f32 v113, v113, v101
  v_mul_f32 v114, v114, v102
  v_mul_f32 v115, v115, v103
  v_cvt_pk_bf16_f32 v148, v115, v114
  v_cvt_pk_bf16_f32 v149, v113, v112
  v_cvt_pk_bf16_f32 v150, v111, v110
  v_cvt_pk_bf16_f32 v151, v109, v108
  s_add_u32 s46, s47, 8192
  buffer_store_dwordx4 v[148:151], v17, s[36:39], s46 offen sc1
  v_and_b32 v96, 0xffff0000, v33
  v_and_b32 v97, 0xffff0000, v35
  v_and_b32 v98, 0xffff0000, v37
  v_and_b32 v99, 0xffff0000, v39
  v_and_b32 v100, 0xffff0000, v41
  v_and_b32 v101, 0xffff0000, v43
  v_and_b32 v102, 0xffff0000, v45
  v_and_b32 v103, 0xffff0000, v47
  v_and_b32 v104, 0xffff0000, v49
  v_and_b32 v105, 0xffff0000, v51
  v_and_b32 v106, 0xffff0000, v53
  v_mul_f32 v108, v96, v95
  v_mul_f32 v109, v97, v95
  v_mul_f32 v110, v98, v95
  v_mul_f32 v111, v99, v95
  v_mul_f32 v112, v100, v95
  v_mul_f32 v113, v101, v95
  v_mul_f32 v114, v102, v95
  v_mul_f32 v115, v103, v95
  v_fmac_f32 v108, v97, v94
  v_fmac_f32 v109, v98, v94
  v_fmac_f32 v110, v99, v94
  v_fmac_f32 v111, v100, v94
  v_fmac_f32 v112, v101, v94
  v_fmac_f32 v113, v102, v94
  v_fmac_f32 v114, v103, v94
  v_fmac_f32 v115, v104, v94
  v_fmac_f32 v108, v98, v93
  v_fmac_f32 v109, v99, v93
  v_fmac_f32 v110, v100, v93
  v_fmac_f32 v111, v101, v93
  v_fmac_f32 v112, v102, v93
  v_fmac_f32 v113, v103, v93
  v_fmac_f32 v114, v104, v93
  v_fmac_f32 v115, v105, v93
  v_fmac_f32 v108, v99, v92
  v_fmac_f32 v109, v100, v92
  v_fmac_f32 v110, v101, v92
  v_fmac_f32 v111, v102, v92
  v_fmac_f32 v112, v103, v92
  v_fmac_f32 v113, v104, v92
  v_fmac_f32 v114, v105, v92
  v_fmac_f32 v115, v106, v92
  v_and_b32 v96, 0xffff0000, v55
  v_and_b32 v97, 0xffff0000, v57
  v_and_b32 v98, 0xffff0000, v59
  v_and_b32 v99, 0xffff0000, v61
  v_and_b32 v100, 0xffff0000, v63
  v_and_b32 v101, 0xffff0000, v65
  v_and_b32 v102, 0xffff0000, v67
  v_and_b32 v103, 0xffff0000, v69
  v_mul_f32 v108, v108, v96
  v_mul_f32 v109, v109, v97
  v_mul_f32 v110, v110, v98
  v_mul_f32 v111, v111, v99
  v_mul_f32 v112, v112, v100
  v_mul_f32 v113, v113, v101
  v_mul_f32 v114, v114, v102
  v_mul_f32 v115, v115, v103
  v_cvt_pk_bf16_f32 v152, v115, v114
  v_cvt_pk_bf16_f32 v153, v113, v112
  v_cvt_pk_bf16_f32 v154, v111, v110
  v_cvt_pk_bf16_f32 v155, v109, v108
  s_add_u32 s46, s47, 12288
  buffer_store_dwordx4 v[152:155], v17, s[36:39], s46 offen sc1
  s_waitcnt vmcnt(0)
  v_mov_b32 v1, 161332
  v_mov_b32 v4, 1
  s_mov_b64 exec, 1
  ds_add_u32 v1, v4
  s_mov_b64 exec, -1
  s_cmp_lg_u32 s42, 8
  s_cbranch_scc1 L1_kvd
  s_cmp_lt_u32 s2, 192
  s_cbranch_scc0 L1_kvd
  v_mov_b32 v1, 161332
Lspin_7:
  ds_read_b32 v4, v1
  s_waitcnt lgkmcnt(0)
  v_readfirstlane_b32 s56, v4
  s_cmp_ge_u32 s56, 3
  s_cbranch_scc1 Lspin_7_x
  s_sleep 1
  s_branch Lspin_7
Lspin_7_x:
  v_mov_b32 v1, 161344
Lspin_8:
  ds_read_b32 v4, v1
  s_waitcnt lgkmcnt(0)
  v_readfirstlane_b32 s56, v4
  s_cmp_ge_u32 s56, 1
  s_cbranch_scc1 Lspin_8_x
  s_sleep 1
  s_branch Lspin_8
Lspin_8_x:
  s_add_u32 s45, s45, 128
  s_lshl_b32 s57, s45, 7
  s_add_u32 s57, s57, 0x14c4000
  v_mov_b32 v1, s57
  v_mov_b32 v4, 1
  s_mov_b64 exec, 1
  buffer_atomic_add v4, v1, s[36:39], 0 offen sc1
  s_mov_b64 exec, -1
L1_kvd:
  s_branch L2_conv
L1_out:
  v_mov_b32 v1, 161324
  v_mov_b32 v5, 1
  s_mov_b64 exec, 1
  ds_add_u32 v1, v5
  s_mov_b64 exec, -1
  v_mov_b32 v1, 161324
Lspin_9:
  ds_read_b32 v5, v1
  s_waitcnt lgkmcnt(0)
  v_readfirstlane_b32 s56, v5
  s_cmp_ge_u32 s56, 8
  s_cbranch_scc1 Lspin_9_x
  s_sleep 1
  s_branch Lspin_9
Lspin_9_x:
  s_cmp_ge_u32 s42, 6
  s_cbranch_scc1 L1_fin
  s_mul_i32 s53, s40, 6
  s_add_u32 s53, s53, s42
  s_lshr_b32 s54, s53, 5
  s_and_b32 s56, s53, 31
  s_mul_i32 s57, s42, 48
  s_add_u32 s57, s57, 32768
  s_lshr_b32 s50, s41, 1
  s_mul_i32 s50, s50, 18432
  s_mul_i32 s51, s56, 147456
  s_add_u32 s50, s50, s51
  s_and_b32 s52, s41, 1
  s_movk_i32 s61, 304
  s_cmp_eq_u32 s54, 2
  s_cbranch_scc1 L1_vout
  s_cmp_eq_u32 s54, 0
  s_cbranch_scc0 L1_kdest
  s_mul_i32 s58, s56, 73728
  s_add_u32 s58, s58, 0x480000
  s_lshl_b32 s60, s41, 9
  s_add_u32 s59, s58, s60
  s_add_u32 s59, s59, 65536
  s_lshl_b32 s60, s41, 12
  s_add_u32 s58, s58, s60
  s_branch L1_destdone
L1_kdest:
  s_lshl_b32 s60, s52, 9
  s_add_u32 s59, s50, s60
  s_add_u32 s59, s59, 8192
  s_lshl_b32 s60, s52, 12
  s_add_u32 s58, s50, s60
L1_destdone:
  v_and_b32 v5, 31, v2
  v_lshrrev_b32 v6, 5, v2
  v_mul_lo_u32 v7, v5, s61
  v_lshl_add_u32 v7, v6, 4, v7
  v_add_u32 v7, s57, v7
  ds_read_b128 v[24:27], v7 offset:0
  ds_read_b128 v[28:31], v7 offset:9728
  ds_read_b128 v[32:35], v7 offset:19456
  ds_read_b128 v[36:39], v7 offset:29184
  v_lshlrev_b32 v8, 2, v5
  v_mul_lo_u32 v8, v8, s61
  v_add_u32 v8, s57, v8
  ds_read_b32 v40, v8 offset:32
  ds_read_b32 v41, v8 offset:336
  ds_read_b32 v42, v8 offset:640
  ds_read_b32 v43, v8 offset:944
  v_lshlrev_b32 v11, 4, v2
  v_mov_b32 v12, 0x80000000
  v_cmp_gt_u32 vcc, 32, v2
  s_nop 1
  v_cndmask_b32 v12, v12, v11, vcc
  s_waitcnt lgkmcnt(7)
  buffer_store_dwordx4 v[24:27], v11, s[36:39], s58 offen offset:0 sc1
  s_waitcnt lgkmcnt(6)
  buffer_store_dwordx4 v[28:31], v11, s[36:39], s58 offen offset:1024 sc1
  s_waitcnt lgkmcnt(5)
  buffer_store_dwordx4 v[32:35], v11, s[36:39], s58 offen offset:2048 sc1
  s_waitcnt lgkmcnt(4)
  buffer_store_dwordx4 v[36:39], v11, s[36:39], s58 offen offset:3072 sc1
  s_waitcnt lgkmcnt(0)
  buffer_store_dwordx4 v[40:43], v12, s[36:39], s59 offen sc1
  s_branch L1_fin
L1_vout:
  v_lshrrev_b32 v9, 2, v2
  v_and_b32 v9, 3, v9
  v_and_b32 v10, 1, v4
  v_lshl_add_u32 v9, v10, 2, v9
  v_mul_lo_u32 v9, v9, s61
  v_and_b32 v13, 3, v2
  v_lshl_add_u32 v9, v13, 3, v9
  v_lshrrev_b32 v13, 1, v4
  v_lshl_add_u32 v9, v13, 5, v9
  v_add_u32 v9, s57, v9
  s_mul_i32 s60, s52, 8*576
  s_add_u32 s63, s50, s60
  s_add_u32 s63, s63, 9216
  v_lshl_add_u32 v14, v13, 4, v3
  v_mul_u32_u24 v13, 288, v10
  v_lshl_add_u32 v13, v14, 4, v13
  v_mov_b32 v15, 0x80000000
  v_cmp_le_u32 vcc, 18, v14
  s_nop 1
  v_cndmask_b32 v13, v13, v15, vcc
  ds_read_b64_tr_b16 v[24:25], v9 offset:0
  ds_read_b64_tr_b16 v[26:27], v9 offset:2432
  ds_read_b64_tr_b16 v[28:29], v9 offset:4864
  ds_read_b64_tr_b16 v[30:31], v9 offset:7296
  ds_read_b64_tr_b16 v[32:33], v9 offset:9728
  ds_read_b64_tr_b16 v[34:35], v9 offset:12160
  ds_read_b64_tr_b16 v[36:37], v9 offset:14592
  ds_read_b64_tr_b16 v[38:39], v9 offset:17024
  s_waitcnt lgkmcnt(6)
  buffer_store_dwordx4 v[24:27], v13, s[36:39], s63 offen offset:0 sc1
  s_waitcnt lgkmcnt(4)
  buffer_store_dwordx4 v[28:31], v13, s[36:39], s63 offen offset:576 sc1
  s_waitcnt lgkmcnt(2)
  buffer_store_dwordx4 v[32:35], v13, s[36:39], s63 offen offset:1152 sc1
  s_waitcnt lgkmcnt(0)
  buffer_store_dwordx4 v[36:39], v13, s[36:39], s63 offen offset:1728 sc1
  ds_read_b64_tr_b16 v[40:41], v9 offset:19456
  ds_read_b64_tr_b16 v[42:43], v9 offset:21888
  ds_read_b64_tr_b16 v[44:45], v9 offset:24320
  ds_read_b64_tr_b16 v[46:47], v9 offset:26752
  ds_read_b64_tr_b16 v[48:49], v9 offset:29184
  ds_read_b64_tr_b16 v[50:51], v9 offset:31616
  ds_read_b64_tr_b16 v[52:53], v9 offset:34048
  ds_read_b64_tr_b16 v[54:55], v9 offset:36480
  s_waitcnt lgkmcnt(6)
  buffer_store_dwordx4 v[40:43], v13, s[36:39], s63 offen offset:2304 sc1
  s_waitcnt lgkmcnt(4)
  buffer_store_dwordx4 v[44:47], v13, s[36:39], s63 offen offset:2880 sc1
  s_waitcnt lgkmcnt(2)
  buffer_store_dwordx4 v[48:51], v13, s[36:39], s63 offen offset:3456 sc1
  s_waitcnt lgkmcnt(0)
  buffer_store_dwordx4 v[52:55], v13, s[36:39], s63 offen offset:4032 sc1
L1_fin:
  s_waitcnt vmcnt(0) lgkmcnt(0)
  v_mov_b32 v1, 161328
  v_mov_b32 v5, 1
  s_mov_b64 exec, 1
  ds_add_u32 v1, v5
  s_mov_b64 exec, -1
  v_mov_b32 v1, 161328
Lspin_10:
  ds_read_b32 v5, v1
  s_waitcnt lgkmcnt(0)
  v_readfirstlane_b32 s56, v5
  s_cmp_ge_u32 s56, 8
  s_cbranch_scc1 Lspin_10_x
  s_sleep 1
  s_branch Lspin_10
Lspin_10_x:
  s_cmp_lg_u32 s42, 0
  s_cbranch_scc1 L2_entry
  v_mov_b32 v1, 161344
Lspin_11:
  ds_read_b32 v5, v1
  s_waitcnt lgkmcnt(0)
  v_readfirstlane_b32 s56, v5
  s_cmp_ge_u32 s56, 1
  s_cbranch_scc1 Lspin_11_x
  s_sleep 1
  s_branch Lspin_11
Lspin_11_x:
  s_lshl_b32 s44, s40, 3
  s_lshr_b32 s45, s41, 1
  s_add_u32 s44, s44, s45
  s_lshl_b32 s57, s44, 7
  s_add_u32 s57, s57, 0x14c4000
  v_mov_b32 v1, s57
  v_mov_b32 v3, 1
  s_mov_b64 exec, 1
  buffer_atomic_add v3, v1, s[36:39], 0 offen sc1
  s_mov_b64 exec, -1
L2_entry:
  s_and_b32 s40, s2, 31
  s_lshr_b32 s41, s2, 5
  v_lshlrev_b32 v3, 4, v2
  s_mul_i32 s43, s40, 147456
  s_cmp_lg_u32 s42, 0
  s_cbranch_scc1 L2_waitgo
  v_min_u32 v5, 2, v2
  v_add_u32 v6, 1, v5
  v_lshrrev_b32 v6, 1, v6
  v_and_b32 v7, 1, v5
  v_sub_u32 v7, 2, v7
  v_cmp_eq_u32 vcc, 0, v5
  v_mov_b32 v8, 0
  s_nop 0
  v_cndmask_b32 v7, v7, v8, vcc
  v_lshlrev_b32 v7, 5, v7
  v_add_u32 v7, s40, v7
  v_mul_u32_u24 v7, 0x2aab, v7
  v_lshrrev_b32 v7, 16, v7
  v_subrev_u32 v6, 1, v6
  v_mov_b32 v8, s41
  v_cndmask_b32 v6, v6, v8, vcc
  v_lshl_add_u32 v5, v7, 3, v6
  v_lshlrev_b32 v5, 7, v5
  v_add_u32 v5, 0x14c4000, v5
  v_mov_b32 v6, 2
  s_mov_b32 s57, 200000
Lpoll_12:
  buffer_load_dword v7, v5, s[36:39], 0 offen sc1
  s_waitcnt vmcnt(0)
  v_cmp_lt_u32 vcc, v7, v6
  s_nop 3
  s_cmp_eq_u64 vcc, 0
  s_cbranch_scc1 Lpoll_12_x
  s_sleep 3
  s_sub_u32 s57, s57, 1
  s_cmp_lg_u32 s57, 0
  s_cbranch_scc1 Lpoll_12
Lpoll_12_x:
  v_mov_b32 v1, 161292
  v_mov_b32 v7, 1
  ds_write_b32 v1, v7
  s_waitcnt lgkmcnt(0)
  s_branch L2_go
L2_waitgo:
  v_mov_b32 v1, 161292
Lspin_13:
  ds_read_b32 v7, v1
  s_waitcnt lgkmcnt(0)
  v_readfirstlane_b32 s56, v7
  s_cmp_ge_u32 s56, 1
  s_cbranch_scc1 Lspin_13_x
  s_sleep 1
  s_branch Lspin_13
Lspin_13_x:
L2_go:
  s_cmp_lt_u32 s42, 4
  s_cbranch_scc0 L2_young
  s_setprio 2
L2_young:
  s_lshr_b32 s46, s42, 2
  s_mul_i32 s45, s46, 3
  s_add_u32 s45, s45, s42
  s_and_b32 s45, s45, 3
  s_lshl_b32 s44, s42, 10
  s_add_u32 s43, s43, s44
  v_mov_b32 v9, 0x80000000
  s_cmp_lt_u32 s42, 2
  s_cselect_b64 vcc, -1, 0
  v_cndmask_b32 v9, v9, v3, vcc
  buffer_load_dwordx4 v[20:23], v3, s[36:39], s43 offen sc1
  s_add_u32 s43, s43, 8192
  buffer_load_dwordx4 v[24:27], v3, s[36:39], s43 offen sc1
  s_add_u32 s43, s43, 8192
  buffer_load_dwordx4 v[28:31], v9, s[36:39], s43 offen sc1
  s_lshl_b32 s47, s41, 3
  s_lshl_b32 s48, s45, 1
  s_add_u32 s47, s47, s48
  s_mul_i32 s48, s40, 73728
  s_add_u32 s48, s48, 0x480000
  s_lshl_b32 s49, s47, 10
  s_add_u32 s49, s49, s48
  s_lshl_b32 s50, s47, 7
  s_add_u32 s50, s50, s48
  s_add_u32 s50, s50, 65536
  v_and_b32 v4, 31, v2
  v_lshrrev_b32 v5, 5, v2
  v_lshlrev_b32 v6, 2, v4
  v_mov_b32 v7, 0x80000000
  v_cmp_eq_u32 vcc, 0, v5
  buffer_load_dwordx4 v[8:11], v3, s[36:39], s49 offen sc1
  buffer_load_dwordx4 v[14:17], v3, s[36:39], s49 offen offset:1024 sc1
  v_cndmask_b32 v7, v7, v6, vcc
  buffer_load_dword v12, v7, s[36:39], s50 offen sc1
  buffer_load_dword v18, v7, s[36:39], s50 offen offset:128 sc1
  v_mov_b32 v13, 0
  v_mov_b32 v19, 0
  v_mov_b32 v109, 0
  v_mov_b32 v111, 0
  v_mov_b32 v1, 0x3f803f80
  v_cmp_eq_u32 vcc, 18, v4
  v_mov_b32 v7, 0
  s_nop 0
  v_cndmask_b32 v1, v7, v1, vcc
  v_mov_b32 v112, v1
  v_mov_b32 v113, v1
  v_mov_b32 v114, v1
  v_mov_b32 v115, v1
  v_mov_b32 v116, v1
  v_mov_b32 v117, v1
  v_mov_b32 v118, v1
  v_mov_b32 v119, v1
  v_mov_b32 v120, v1
  v_mov_b32 v121, v1
  v_mov_b32 v122, v1
  v_mov_b32 v123, v1
  v_mov_b32 v124, v1
  v_mov_b32 v125, v1
  v_mov_b32 v126, v1
  v_mov_b32 v127, v1
  v_lshlrev_b32 v160, 4, v2
  v_add_u32 v161, 8192, v6
  v_mul_u32_u24 v162, 288, v5
  v_lshl_add_u32 v162, v4, 4, v162
  v_add_u32 v162, 9216, v162
  s_mov_b32 s52, 0x3ffff
  s_mov_b32 s53, 0x3ffff
  s_mov_b32 s60, 0
  s_mov_b32 s61, 1
  s_lshl_b32 s62, s45, 2
  s_add_u32 s62, s62, 161296
  v_mov_b32 v166, s62
  v_mov_b32 v167, 1
  v_add_u32 v3, s44, v3
  s_waitcnt vmcnt(6)
  ds_write_b128 v3, v[20:23] offset:0
  s_waitcnt vmcnt(5)
  ds_write_b128 v3, v[24:27] offset:8192
  s_waitcnt vmcnt(4)
  s_cmp_ge_u32 s42, 2
  s_cbranch_scc1 L2_no5
  ds_write_b128 v3, v[28:31] offset:16384
L2_no5:
  s_waitcnt vmcnt(0) lgkmcnt(0)
  v_mov_b32 v1, 161280
  v_mov_b32 v3, 1
  s_mov_b64 exec, 1
  ds_add_u32 v1, v3
  s_mov_b64 exec, -1
  v_mov_b32 v1, 161280
Lspin_14:
  ds_read_b32 v3, v1
  s_waitcnt lgkmcnt(0)
  v_readfirstlane_b32 s56, v3
  s_cmp_ge_u32 s56, 8
  s_cbranch_scc1 Lspin_14_x
  s_sleep 1
  s_branch Lspin_14
Lspin_14_x:
  v_mov_b32 v68, 0
  v_mov_b32 v84, 0
  v_mov_b32 v69, 0
  v_mov_b32 v85, 0
  v_mov_b32 v70, 0
  v_mov_b32 v86, 0
  v_mov_b32 v71, 0
  v_mov_b32 v87, 0
  v_mov_b32 v72, 0
  v_mov_b32 v88, 0
  v_mov_b32 v73, 0
  v_mov_b32 v89, 0
  v_mov_b32 v74, 0
  v_mov_b32 v90, 0
  v_mov_b32 v75, 0
  v_mov_b32 v91, 0
  v_mov_b32 v76, 0
  v_mov_b32 v92, 0
  v_mov_b32 v77, 0
  v_mov_b32 v93, 0
  v_mov_b32 v78, 0
  v_mov_b32 v94, 0
  v_mov_b32 v79, 0
  v_mov_b32 v95, 0
  v_mov_b32 v80, 0
  v_mov_b32 v96, 0
  v_mov_b32 v81, 0
  v_mov_b32 v97, 0
  v_mov_b32 v82, 0
  v_mov_b32 v98, 0
  v_mov_b32 v83, 0
  v_mov_b32 v99, 0
  v_mov_b32 v60, 0
  v_mov_b32 v61, 0
  v_mov_b32 v62, 0
  v_mov_b32 v63, 0
  v_mov_b32 v64, 0
  v_mov_b32 v65, 0
  v_mov_b32 v66, 0
  v_mov_b32 v67, 0
  s_mov_b32 s54, s46
  s_lshr_b32 s56, s54, 1
  s_mul_i32 s56, s56, 18432
  s_and_b32 s59, s54, 1
  s_lshl_b32 s57, s59, 12
  s_add_u32 s57, s57, s56
  s_lshl_b32 s58, s59, 9
  s_add_u32 s58, s58, s56
  s_mul_i32 s63, s59, 4608
  s_add_u32 s63, s63, s56
  v_add_u32 v163, s57, v160
  v_add_u32 v164, s58, v161
  v_add_u32 v165, s63, v162
  ds_read_b128 v[100:103], v163
  ds_read_b32 v108, v164
  s_waitcnt lgkmcnt(0)
  v_mfma_f32_32x32x16_bf16 v[20:35], v[100:103], v[8:11], 0
  v_mfma_f32_32x32x8_bf16 v[20:35], v[108:109], v[12:13], v[20:35]
  s_nop 7
  s_nop 3
L2_stage0:
  v_mfma_f32_32x32x16_bf16 v[36:51], v[100:103], v[14:17], 0
  s_mov_b64 exec, s[52:53]
  ds_read_b128 v[112:115], v165 offset:0
  ds_read_b128 v[116:119], v165 offset:576
  s_mov_b64 exec, -1
  v_exp_f32 v20, v20
  v_exp_f32 v21, v21
  v_exp_f32 v22, v22
  v_exp_f32 v23, v23
  v_mfma_f32_32x32x16_bf16 v[84:99], v[120:123], v[60:63], v[84:99]
  v_exp_f32 v24, v24
  v_exp_f32 v25, v25
  v_cvt_pk_bf16_f32 v52, v20, v21
  v_exp_f32 v26, v26
  v_exp_f32 v27, v27
  v_cvt_pk_bf16_f32 v53, v22, v23
  ds_read_b128 v[104:107], v163 offset:1024
  ds_read_b32 v110, v164 offset:128
  v_exp_f32 v28, v28
  v_mfma_f32_32x32x8_bf16 v[36:51], v[108:109], v[18:19], v[36:51]
  v_exp_f32 v29, v29
  v_cvt_pk_bf16_f32 v54, v24, v25
  v_exp_f32 v30, v30
  v_exp_f32 v31, v31
  v_cvt_pk_bf16_f32 v55, v26, v27
  v_mfma_f32_32x32x16_bf16 v[84:99], v[124:127], v[64:67], v[84:99]
  v_exp_f32 v32, v32
  v_exp_f32 v33, v33
  v_cvt_pk_bf16_f32 v56, v28, v29
  v_exp_f32 v34, v34
  v_exp_f32 v35, v35
  v_cvt_pk_bf16_f32 v57, v30, v31
  v_cvt_pk_bf16_f32 v58, v32, v33
  v_cvt_pk_bf16_f32 v59, v34, v35
  s_waitcnt lgkmcnt(0)
  v_mfma_f32_32x32x16_bf16 v[20:35], v[104:107], v[8:11], 0
  v_exp_f32 v36, v36
  v_exp_f32 v37, v37
  v_exp_f32 v38, v38
  v_exp_f32 v39, v39
  v_mfma_f32_32x32x16_bf16 v[68:83], v[112:115], v[52:55], v[68:83]
  v_exp_f32 v40, v40
  v_exp_f32 v41, v41
  v_cvt_pk_bf16_f32 v60, v36, v37
  v_exp_f32 v42, v42
  v_exp_f32 v43, v43
  v_cvt_pk_bf16_f32 v61, v38, v39
  v_exp_f32 v44, v44
  v_mfma_f32_32x32x8_bf16 v[20:35], v[110:111], v[12:13], v[20:35]
  v_exp_f32 v45, v45
  v_cvt_pk_bf16_f32 v62, v40, v41
  v_exp_f32 v46, v46
  v_exp_f32 v47, v47
  v_cvt_pk_bf16_f32 v63, v42, v43
  v_mfma_f32_32x32x16_bf16 v[68:83], v[116:119], v[56:59], v[68:83]
  v_exp_f32 v48, v48
  v_exp_f32 v49, v49
  v_cvt_pk_bf16_f32 v64, v44, v45
  v_exp_f32 v50, v50
  v_exp_f32 v51, v51
  v_cvt_pk_bf16_f32 v65, v46, v47
  v_cvt_pk_bf16_f32 v66, v48, v49
  v_cvt_pk_bf16_f32 v67, v50, v51
  v_mfma_f32_32x32x16_bf16 v[36:51], v[104:107], v[14:17], 0
  s_mov_b64 exec, s[52:53]
  ds_read_b128 v[120:123], v165 offset:1152
  ds_read_b128 v[124:127], v165 offset:1728
  s_mov_b64 exec, -1
  v_exp_f32 v20, v20
  v_exp_f32 v21, v21
  v_exp_f32 v22, v22
  v_exp_f32 v23, v23
  v_mfma_f32_32x32x16_bf16 v[84:99], v[112:115], v[60:63], v[84:99]
  v_exp_f32 v24, v24
  v_exp_f32 v25, v25
  v_cvt_pk_bf16_f32 v52, v20, v21
  v_exp_f32 v26, v26
  v_exp_f32 v27, v27
  v_cvt_pk_bf16_f32 v53, v22, v23
  ds_read_b128 v[100:103], v163 offset:2048
  ds_read_b32 v108, v164 offset:256
  v_exp_f32 v28, v28
  v_mfma_f32_32x32x8_bf16 v[36:51], v[110:111], v[18:19], v[36:51]
  v_exp_f32 v29, v29
  v_cvt_pk_bf16_f32 v54, v24, v25
  v_exp_f32 v30, v30
  v_exp_f32 v31, v31
  v_cvt_pk_bf16_f32 v55, v26, v27
  v_mfma_f32_32x32x16_bf16 v[84:99], v[116:119], v[64:67], v[84:99]
  v_exp_f32 v32, v32
  v_exp_f32 v33, v33
  v_cvt_pk_bf16_f32 v56, v28, v29
  v_exp_f32 v34, v34
  v_exp_f32 v35, v35
  v_cvt_pk_bf16_f32 v57, v30, v31
  v_cvt_pk_bf16_f32 v58, v32, v33
  v_cvt_pk_bf16_f32 v59, v34, v35
  s_waitcnt lgkmcnt(0)
  v_mfma_f32_32x32x16_bf16 v[20:35], v[100:103], v[8:11], 0
  v_exp_f32 v36, v36
  v_exp_f32 v37, v37
  v_exp_f32 v38, v38
  v_exp_f32 v39, v39
  v_mfma_f32_32x32x16_bf16 v[68:83], v[120:123], v[52:55], v[68:83]
  v_exp_f32 v40, v40
  v_exp_f32 v41, v41
  v_cvt_pk_bf16_f32 v60, v36, v37
  v_exp_f32 v42, v42
  v_exp_f32 v43, v43
  v_cvt_pk_bf16_f32 v61, v38, v39
  v_exp_f32 v44, v44
  v_mfma_f32_32x32x8_bf16 v[20:35], v[108:109], v[12:13], v[20:35]
  v_exp_f32 v45, v45
  v_cvt_pk_bf16_f32 v62, v40, v41
  v_exp_f32 v46, v46
  v_exp_f32 v47, v47
  v_cvt_pk_bf16_f32 v63, v42, v43
  v_mfma_f32_32x32x16_bf16 v[68:83], v[124:127], v[56:59], v[68:83]
  v_exp_f32 v48, v48
  v_exp_f32 v49, v49
  v_cvt_pk_bf16_f32 v64, v44, v45
  v_exp_f32 v50, v50
  v_exp_f32 v51, v51
  v_cvt_pk_bf16_f32 v65, v46, v47
  v_cvt_pk_bf16_f32 v66, v48, v49
  v_cvt_pk_bf16_f32 v67, v50, v51
  v_mfma_f32_32x32x16_bf16 v[36:51], v[100:103], v[14:17], 0
  s_mov_b64 exec, s[52:53]
  ds_read_b128 v[112:115], v165 offset:2304
  ds_read_b128 v[116:119], v165 offset:2880
  s_mov_b64 exec, 1
  ds_add_rtn_u32 v7, v166, v167
  s_mov_b64 exec, -1
  v_exp_f32 v20, v20
  v_exp_f32 v21, v21
  v_exp_f32 v22, v22
  v_exp_f32 v23, v23
  v_mfma_f32_32x32x16_bf16 v[84:99], v[120:123], v[60:63], v[84:99]
  v_exp_f32 v24, v24
  v_exp_f32 v25, v25
  v_cvt_pk_bf16_f32 v52, v20, v21
  v_exp_f32 v26, v26
  v_exp_f32 v27, v27
  v_cvt_pk_bf16_f32 v53, v22, v23
  ds_read_b128 v[104:107], v163 offset:3072
  ds_read_b32 v110, v164 offset:384
  v_exp_f32 v28, v28
  v_mfma_f32_32x32x8_bf16 v[36:51], v[108:109], v[18:19], v[36:51]
  v_exp_f32 v29, v29
  v_cvt_pk_bf16_f32 v54, v24, v25
  v_exp_f32 v30, v30
  v_exp_f32 v31, v31
  v_cvt_pk_bf16_f32 v55, v26, v27
  v_mfma_f32_32x32x16_bf16 v[84:99], v[124:127], v[64:67], v[84:99]
  v_exp_f32 v32, v32
  v_exp_f32 v33, v33
  v_cvt_pk_bf16_f32 v56, v28, v29
  v_exp_f32 v34, v34
  v_exp_f32 v35, v35
  v_cvt_pk_bf16_f32 v57, v30, v31
  v_cvt_pk_bf16_f32 v58, v32, v33
  v_cvt_pk_bf16_f32 v59, v34, v35
  s_waitcnt lgkmcnt(0)
  v_readfirstlane_b32 s55, v7
  s_cmp_lt_u32 s55, 16
  s_cselect_b32 s64, s55, s54
  s_cbranch_scc1 L2_more0
  s_setprio 3
L2_more0:
  s_lshr_b32 s56, s64, 1
  s_mul_i32 s56, s56, 18432
  s_and_b32 s59, s64, 1
  s_lshl_b32 s57, s59, 12
  s_add_u32 s57, s57, s56
  s_lshl_b32 s58, s59, 9
  s_add_u32 s58, s58, s56
  s_mul_i32 s63, s59, 4608
  s_add_u32 s63, s63, s56
  s_lshr_b32 s64, s64, 1
  s_cmp_lt_u32 s64, s61
  s_cbranch_scc1 L2_landed0
  v_mov_b32 v1, 161284
L2_spinL0:
  ds_read_b32 v3, v1
  s_waitcnt lgkmcnt(0)
  v_readfirstlane_b32 s61, v3
  s_cmp_lt_u32 s64, s61
  s_cbranch_scc1 L2_landed0
  s_sleep 1
  s_branch L2_spinL0
L2_landed0:
  v_add_u32 v163, s57, v160
  v_add_u32 v164, s58, v161
  v_mfma_f32_32x32x16_bf16 v[20:35], v[104:107], v[8:11], 0
  v_exp_f32 v36, v36
  v_exp_f32 v37, v37
  v_exp_f32 v38, v38
  v_exp_f32 v39, v39
  v_mfma_f32_32x32x16_bf16 v[68:83], v[112:115], v[52:55], v[68:83]
  v_exp_f32 v40, v40
  v_exp_f32 v41, v41
  v_cvt_pk_bf16_f32 v60, v36, v37
  v_exp_f32 v42, v42
  v_exp_f32 v43, v43
  v_cvt_pk_bf16_f32 v61, v38, v39
  v_exp_f32 v44, v44
  v_mfma_f32_32x32x8_bf16 v[20:35], v[110:111], v[12:13], v[20:35]
  v_exp_f32 v45, v45
  v_cvt_pk_bf16_f32 v62, v40, v41
  v_exp_f32 v46, v46
  v_exp_f32 v47, v47
  v_cvt_pk_bf16_f32 v63, v42, v43
  v_mfma_f32_32x32x16_bf16 v[68:83], v[116:119], v[56:59], v[68:83]
  v_exp_f32 v48, v48
  v_exp_f32 v49, v49
  v_cvt_pk_bf16_f32 v64, v44, v45
  v_exp_f32 v50, v50
  v_exp_f32 v51, v51
  v_cvt_pk_bf16_f32 v65, v46, v47
  v_cvt_pk_bf16_f32 v66, v48, v49
  v_cvt_pk_bf16_f32 v67, v50, v51
  v_mfma_f32_32x32x16_bf16 v[36:51], v[104:107], v[14:17], 0
  s_mov_b64 exec, s[52:53]
  ds_read_b128 v[120:123], v165 offset:3456
  ds_read_b128 v[124:127], v165 offset:4032
  s_mov_b64 exec, -1
  v_exp_f32 v20, v20
  v_exp_f32 v21, v21
  v_exp_f32 v22, v22
  v_exp_f32 v23, v23
  v_mfma_f32_32x32x16_bf16 v[84:99], v[112:115], v[60:63], v[84:99]
  v_exp_f32 v24, v24
  v_exp_f32 v25, v25
  v_cvt_pk_bf16_f32 v52, v20, v21
  v_exp_f32 v26, v26
  v_exp_f32 v27, v27
  v_cvt_pk_bf16_f32 v53, v22, v23
  ds_read_b128 v[100:103], v163 offset:0
  ds_read_b32 v108, v164 offset:0
  v_exp_f32 v28, v28
  v_mfma_f32_32x32x8_bf16 v[36:51], v[110:111], v[18:19], v[36:51]
  v_exp_f32 v29, v29
  v_cvt_pk_bf16_f32 v54, v24, v25
  v_exp_f32 v30, v30
  v_exp_f32 v31, v31
  v_cvt_pk_bf16_f32 v55, v26, v27
  v_mfma_f32_32x32x16_bf16 v[84:99], v[116:119], v[64:67], v[84:99]
  v_exp_f32 v32, v32
  v_exp_f32 v33, v33
  v_cvt_pk_bf16_f32 v56, v28, v29
  v_exp_f32 v34, v34
  v_exp_f32 v35, v35
  v_cvt_pk_bf16_f32 v57, v30, v31
  v_cvt_pk_bf16_f32 v58, v32, v33
  v_cvt_pk_bf16_f32 v59, v34, v35
  s_waitcnt lgkmcnt(0)
  v_mfma_f32_32x32x16_bf16 v[20:35], v[100:103], v[8:11], 0
  v_exp_f32 v36, v36
  v_exp_f32 v37, v37
  v_exp_f32 v38, v38
  v_exp_f32 v39, v39
  v_mfma_f32_32x32x16_bf16 v[68:83], v[120:123], v[52:55], v[68:83]
  v_exp_f32 v40, v40
  v_exp_f32 v41, v41
  v_cvt_pk_bf16_f32 v60, v36, v37
  v_exp_f32 v42, v42
  v_exp_f32 v43, v43
  v_cvt_pk_bf16_f32 v61, v38, v39
  v_exp_f32 v44, v44
  v_mfma_f32_32x32x8_bf16 v[20:35], v[108:109], v[12:13], v[20:35]
  v_exp_f32 v45, v45
  v_cvt_pk_bf16_f32 v62, v40, v41
  v_exp_f32 v46, v46
  v_exp_f32 v47, v47
  v_cvt_pk_bf16_f32 v63, v42, v43
  v_mfma_f32_32x32x16_bf16 v[68:83], v[124:127], v[56:59], v[68:83]
  v_exp_f32 v48, v48
  v_exp_f32 v49, v49
  v_cvt_pk_bf16_f32 v64, v44, v45
  v_exp_f32 v50, v50
  v_exp_f32 v51, v51
  v_cvt_pk_bf16_f32 v65, v46, v47
  v_cvt_pk_bf16_f32 v66, v48, v49
  v_cvt_pk_bf16_f32 v67, v50, v51
  v_add_u32 v165, s63, v162
  s_mov_b32 s54, s55
  s_cmp_lt_u32 s54, 16
  s_cbranch_scc1 L2_stage0
  v_mfma_f32_32x32x16_bf16 v[84:99], v[120:123], v[60:63], v[84:99]
  v_mfma_f32_32x32x16_bf16 v[84:99], v[124:127], v[64:67], v[84:99]
  s_nop 7
  s_nop 3
  v_mov_b32 v1, 0x21800000
  v_mov_b32 v3, 0x5d800000
  v_cmp_le_f32 s[56:57], v1, v78
  v_cmp_ge_f32 s[58:59], v3, v78
  s_and_b64 s[56:57], s[56:57], s[58:59]
  v_cmp_le_f32 s[58:59], v1, v94
  s_and_b64 s[56:57], s[56:57], s[58:59]
  v_cmp_ge_f32 s[58:59], v3, v94
  s_and_b64 s[56:57], s[56:57], s[58:59]
  s_cmp_eq_u32 s56, -1
  s_cbranch_scc1 L2_ok
  v_mov_b32 v1, 161288
  v_mov_b32 v3, 1
  ds_write_b32 v1, v3
  s_waitcnt lgkmcnt(0)
L2_ok:
  s_barrier
  v_mov_b32 v1, 161288
  ds_read_b32 v3, v1
  s_waitcnt lgkmcnt(0)
  v_readfirstlane_b32 s56, v3
  s_cmp_eq_u32 s56, 0
  s_cbranch_scc1 L2_exch
  s_mov_b32 s60, 1
  v_mov_b32 v166, 0xff800000
  v_mov_b32 v167, 0xff800000
  s_lshl_b32 s54, s46, 2
  s_add_u32 s58, s54, 4
L2_maxstage:
  s_mul_i32 s55, s54, 18432
  v_add_u32 v1, s55, v160
  v_add_u32 v3, s55, v161
  s_mov_b32 s55, 0
L2_maxtile:
  ds_read_b128 v[100:103], v1
  ds_read_b32 v108, v3
  s_waitcnt lgkmcnt(0)
  v_mfma_f32_32x32x16_bf16 v[20:35], v[100:103], v[8:11], 0
  v_mfma_f32_32x32x16_bf16 v[36:51], v[100:103], v[14:17], 0
  v_mfma_f32_32x32x8_bf16 v[20:35], v[108:109], v[12:13], v[20:35]
  v_mfma_f32_32x32x8_bf16 v[36:51], v[108:109], v[18:19], v[36:51]
  s_nop 7
  s_nop 7
  v_max_f32 v166, v166, v20
  v_max_f32 v167, v167, v36
  v_max_f32 v166, v166, v21
  v_max_f32 v167, v167, v37
  v_max_f32 v166, v166, v22
  v_max_f32 v167, v167, v38
  v_max_f32 v166, v166, v23
  v_max_f32 v167, v167, v39
  v_max_f32 v166, v166, v24
  v_max_f32 v167, v167, v40
  v_max_f32 v166, v166, v25
  v_max_f32 v167, v167, v41
  v_max_f32 v166, v166, v26
  v_max_f32 v167, v167, v42
  v_max_f32 v166, v166, v27
  v_max_f32 v167, v167, v43
  v_max_f32 v166, v166, v28
  v_max_f32 v167, v167, v44
  v_max_f32 v166, v166, v29
  v_max_f32 v167, v167, v45
  v_max_f32 v166, v166, v30
  v_max_f32 v167, v167, v46
  v_max_f32 v166, v166, v31
  v_max_f32 v167, v167, v47
  v_max_f32 v166, v166, v32
  v_max_f32 v167, v167, v48
  v_max_f32 v166, v166, v33
  v_max_f32 v167, v167, v49
  v_max_f32 v166, v166, v34
  v_max_f32 v167, v167, v50
  v_max_f32 v166, v166, v35
  v_max_f32 v167, v167, v51
  v_add_u32 v1, 1024, v1
  v_add_u32 v3, 128, v3
  s_add_u32 s55, s55, 1
  s_cmp_lt_u32 s55, 8
  s_cbranch_scc1 L2_maxtile
  s_add_u32 s54, s54, 1
  s_cmp_lt_u32 s54, s58
  s_cbranch_scc1 L2_maxstage
  v_xor_b32 v1, 32, v2
  v_lshlrev_b32 v1, 2, v1
  ds_bpermute_b32 v3, v1, v166
  s_waitcnt lgkmcnt(0)
  v_max_f32 v166, v166, v3
  ds_bpermute_b32 v3, v1, v167
  s_waitcnt lgkmcnt(0)
  v_max_f32 v167, v167, v3
  s_lshl_b32 s55, s2, 2
  s_add_u32 s55, s55, s45
  s_lshl_b32 s55, s55, 1
  s_add_u32 s55, s55, s46
  s_lshl_b32 s55, s55, 9
  s_add_u32 s55, s55, 0x13c4000
  v_lshlrev_b32 v1, 3, v2
  buffer_store_dwordx2 v[166:167], v1, s[36:39], s55 offen sc0 sc1
  v_mov_b32 v3, s62
  v_mov_b32 v6, 2
  ds_write_b32 v3, v6
  s_waitcnt vmcnt(0) lgkmcnt(0)
  s_barrier
  s_xor_b32 s56, s55, 512
  buffer_load_dwordx2 v[6:7], v1, s[36:39], s56 offen sc0 sc1
  s_waitcnt vmcnt(0)
  v_max_f32 v166, v166, v6
  v_max_f32 v167, v167, v7
  v_sub_f32 v128, 0, v166
  v_sub_f32 v144, 0, v167
  v_sub_f32 v129, 0, v166
  v_sub_f32 v145, 0, v167
  v_sub_f32 v130, 0, v166
  v_sub_f32 v146, 0, v167
  v_sub_f32 v131, 0, v166
  v_sub_f32 v147, 0, v167
  v_sub_f32 v132, 0, v166
  v_sub_f32 v148, 0, v167
  v_sub_f32 v133, 0, v166
  v_sub_f32 v149, 0, v167
  v_sub_f32 v134, 0, v166
  v_sub_f32 v150, 0, v167
  v_sub_f32 v135, 0, v166
  v_sub_f32 v151, 0, v167
  v_sub_f32 v136, 0, v166
  v_sub_f32 v152, 0, v167
  v_sub_f32 v137, 0, v166
  v_sub_f32 v153, 0, v167
  v_sub_f32 v138, 0, v166
  v_sub_f32 v154, 0, v167
  v_sub_f32 v139, 0, v166
  v_sub_f32 v155, 0, v167
  v_sub_f32 v140, 0, v166
  v_sub_f32 v156, 0, v167
  v_sub_f32 v141, 0, v166
  v_sub_f32 v157, 0, v167
  v_sub_f32 v142, 0, v166
  v_sub_f32 v158, 0, v167
  v_sub_f32 v143, 0, v166
  v_sub_f32 v159, 0, v167
  v_mov_b32 v166, s62
  v_mov_b32 v167, 1
  v_mov_b32 v68, 0
  v_mov_b32 v84, 0
  v_mov_b32 v69, 0
  v_mov_b32 v85, 0
  v_mov_b32 v70, 0
  v_mov_b32 v86, 0
  v_mov_b32 v71, 0
  v_mov_b32 v87, 0
  v_mov_b32 v72, 0
  v_mov_b32 v88, 0
  v_mov_b32 v73, 0
  v_mov_b32 v89, 0
  v_mov_b32 v74, 0
  v_mov_b32 v90, 0
  v_mov_b32 v75, 0
  v_mov_b32 v91, 0
  v_mov_b32 v76, 0
  v_mov_b32 v92, 0
  v_mov_b32 v77, 0
  v_mov_b32 v93, 0
  v_mov_b32 v78, 0
  v_mov_b32 v94, 0
  v_mov_b32 v79, 0
  v_mov_b32 v95, 0
  v_mov_b32 v80, 0
  v_mov_b32 v96, 0
  v_mov_b32 v81, 0
  v_mov_b32 v97, 0
  v_mov_b32 v82, 0
  v_mov_b32 v98, 0
  v_mov_b32 v83, 0
  v_mov_b32 v99, 0
  v_mov_b32 v60, 0
  v_mov_b32 v61, 0
  v_mov_b32 v62, 0
  v_mov_b32 v63, 0
  v_mov_b32 v64, 0
  v_mov_b32 v65, 0
  v_mov_b32 v66, 0
  v_mov_b32 v67, 0
  s_mov_b32 s54, s46
  s_lshr_b32 s56, s54, 1
  s_mul_i32 s56, s56, 18432
  s_and_b32 s59, s54, 1
  s_lshl_b32 s57, s59, 12
  s_add_u32 s57, s57, s56
  s_lshl_b32 s58, s59, 9
  s_add_u32 s58, s58, s56
  s_mul_i32 s63, s59, 4608
  s_add_u32 s63, s63, s56
  v_add_u32 v163, s57, v160
  v_add_u32 v164, s58, v161
  v_add_u32 v165, s63, v162
  ds_read_b128 v[100:103], v163
  ds_read_b32 v108, v164
  s_waitcnt lgkmcnt(0)
  v_mfma_f32_32x32x16_bf16 v[20:35], v[100:103], v[8:11], v[128:143]
  v_mfma_f32_32x32x8_bf16 v[20:35], v[108:109], v[12:13], v[20:35]
  s_nop 7
  s_nop 3
L2_stage1:
  v_mfma_f32_32x32x16_bf16 v[36:51], v[100:103], v[14:17], v[144:159]
  s_mov_b64 exec, s[52:53]
  ds_read_b128 v[112:115], v165 offset:0
  ds_read_b128 v[116:119], v165 offset:576
  s_mov_b64 exec, -1
  v_exp_f32 v20, v20
  v_exp_f32 v21, v21
  v_exp_f32 v22, v22
  v_exp_f32 v23, v23
  v_mfma_f32_32x32x16_bf16 v[84:99], v[120:123], v[60:63], v[84:99]
  v_exp_f32 v24, v24
  v_exp_f32 v25, v25
  v_cvt_pk_bf16_f32 v52, v20, v21
  v_exp_f32 v26, v26
  v_exp_f32 v27, v27
  v_cvt_pk_bf16_f32 v53, v22, v23
  ds_read_b128 v[104:107], v163 offset:1024
  ds_read_b32 v110, v164 offset:128
  v_exp_f32 v28, v28
  v_mfma_f32_32x32x8_bf16 v[36:51], v[108:109], v[18:19], v[36:51]
  v_exp_f32 v29, v29
  v_cvt_pk_bf16_f32 v54, v24, v25
  v_exp_f32 v30, v30
  v_exp_f32 v31, v31
  v_cvt_pk_bf16_f32 v55, v26, v27
  v_mfma_f32_32x32x16_bf16 v[84:99], v[124:127], v[64:67], v[84:99]
  v_exp_f32 v32, v32
  v_exp_f32 v33, v33
  v_cvt_pk_bf16_f32 v56, v28, v29
  v_exp_f32 v34, v34
  v_exp_f32 v35, v35
  v_cvt_pk_bf16_f32 v57, v30, v31
  v_cvt_pk_bf16_f32 v58, v32, v33
  v_cvt_pk_bf16_f32 v59, v34, v35
  s_waitcnt lgkmcnt(0)
  v_mfma_f32_32x32x16_bf16 v[20:35], v[104:107], v[8:11], v[128:143]
  v_exp_f32 v36, v36
  v_exp_f32 v37, v37
  v_exp_f32 v38, v38
  v_exp_f32 v39, v39
  v_mfma_f32_32x32x16_bf16 v[68:83], v[112:115], v[52:55], v[68:83]
  v_exp_f32 v40, v40
  v_exp_f32 v41, v41
  v_cvt_pk_bf16_f32 v60, v36, v37
  v_exp_f32 v42, v42
  v_exp_f32 v43, v43
  v_cvt_pk_bf16_f32 v61, v38, v39
  v_exp_f32 v44, v44
  v_mfma_f32_32x32x8_bf16 v[20:35], v[110:111], v[12:13], v[20:35]
  v_exp_f32 v45, v45
  v_cvt_pk_bf16_f32 v62, v40, v41
  v_exp_f32 v46, v46
  v_exp_f32 v47, v47
  v_cvt_pk_bf16_f32 v63, v42, v43
  v_mfma_f32_32x32x16_bf16 v[68:83], v[116:119], v[56:59], v[68:83]
  v_exp_f32 v48, v48
  v_exp_f32 v49, v49
  v_cvt_pk_bf16_f32 v64, v44, v45
  v_exp_f32 v50, v50
  v_exp_f32 v51, v51
  v_cvt_pk_bf16_f32 v65, v46, v47
  v_cvt_pk_bf16_f32 v66, v48, v49
  v_cvt_pk_bf16_f32 v67, v50, v51
  v_mfma_f32_32x32x16_bf16 v[36:51], v[104:107], v[14:17], v[144:159]
  s_mov_b64 exec, s[52:53]
  ds_read_b128 v[120:123], v165 offset:1152
  ds_read_b128 v[124:127], v165 offset:1728
  s_mov_b64 exec, -1
  v_exp_f32 v20, v20
  v_exp_f32 v21, v21
  v_exp_f32 v22, v22
  v_exp_f32 v23, v23
  v_mfma_f32_32x32x16_bf16 v[84:99], v[112:115], v[60:63], v[84:99]
  v_exp_f32 v24, v24
  v_exp_f32 v25, v25
  v_cvt_pk_bf16_f32 v52, v20, v21
  v_exp_f32 v26, v26
  v_exp_f32 v27, v27
  v_cvt_pk_bf16_f32 v53, v22, v23
  ds_read_b128 v[100:103], v163 offset:2048
  ds_read_b32 v108, v164 offset:256
  v_exp_f32 v28, v28
  v_mfma_f32_32x32x8_bf16 v[36:51], v[110:111], v[18:19], v[36:51]
  v_exp_f32 v29, v29
  v_cvt_pk_bf16_f32 v54, v24, v25
  v_exp_f32 v30, v30
  v_exp_f32 v31, v31
  v_cvt_pk_bf16_f32 v55, v26, v27
  v_mfma_f32_32x32x16_bf16 v[84:99], v[116:119], v[64:67], v[84:99]
  v_exp_f32 v32, v32
  v_exp_f32 v33, v33
  v_cvt_pk_bf16_f32 v56, v28, v29
  v_exp_f32 v34, v34
  v_exp_f32 v35, v35
  v_cvt_pk_bf16_f32 v57, v30, v31
  v_cvt_pk_bf16_f32 v58, v32, v33
  v_cvt_pk_bf16_f32 v59, v34, v35
  s_waitcnt lgkmcnt(0)
  v_mfma_f32_32x32x16_bf16 v[20:35], v[100:103], v[8:11], v[128:143]
  v_exp_f32 v36, v36
  v_exp_f32 v37, v37
  v_exp_f32 v38, v38
  v_exp_f32 v39, v39
  v_mfma_f32_32x32x16_bf16 v[68:83], v[120:123], v[52:55], v[68:83]
  v_exp_f32 v40, v40
  v_exp_f32 v41, v41
  v_cvt_pk_bf16_f32 v60, v36, v37
  v_exp_f32 v42, v42
  v_exp_f32 v43, v43
  v_cvt_pk_bf16_f32 v61, v38, v39
  v_exp_f32 v44, v44
  v_mfma_f32_32x32x8_bf16 v[20:35], v[108:109], v[12:13], v[20:35]
  v_exp_f32 v45, v45
  v_cvt_pk_bf16_f32 v62, v40, v41
  v_exp_f32 v46, v46
  v_exp_f32 v47, v47
  v_cvt_pk_bf16_f32 v63, v42, v43
  v_mfma_f32_32x32x16_bf16 v[68:83], v[124:127], v[56:59], v[68:83]
  v_exp_f32 v48, v48
  v_exp_f32 v49, v49
  v_cvt_pk_bf16_f32 v64, v44, v45
  v_exp_f32 v50, v50
  v_exp_f32 v51, v51
  v_cvt_pk_bf16_f32 v65, v46, v47
  v_cvt_pk_bf16_f32 v66, v48, v49
  v_cvt_pk_bf16_f32 v67, v50, v51
  v_mfma_f32_32x32x16_bf16 v[36:51], v[100:103], v[14:17], v[144:159]
  s_mov_b64 exec, s[52:53]
  ds_read_b128 v[112:115], v165 offset:2304
  ds_read_b128 v[116:119], v165 offset:2880
  s_mov_b64 exec, 1
  ds_add_rtn_u32 v7, v166, v167
  s_mov_b64 exec, -1
  v_exp_f32 v20, v20
  v_exp_f32 v21, v21
  v_exp_f32 v22, v22
  v_exp_f32 v23, v23
  v_mfma_f32_32x32x16_bf16 v[84:99], v[120:123], v[60:63], v[84:99]
  v_exp_f32 v24, v24
  v_exp_f32 v25, v25
  v_cvt_pk_bf16_f32 v52, v20, v21
  v_exp_f32 v26, v26
  v_exp_f32 v27, v27
  v_cvt_pk_bf16_f32 v53, v22, v23
  ds_read_b128 v[104:107], v163 offset:3072
  ds_read_b32 v110, v164 offset:384
  v_exp_f32 v28, v28
  v_mfma_f32_32x32x8_bf16 v[36:51], v[108:109], v[18:19], v[36:51]
  v_exp_f32 v29, v29
  v_cvt_pk_bf16_f32 v54, v24, v25
  v_exp_f32 v30, v30
  v_exp_f32 v31, v31
  v_cvt_pk_bf16_f32 v55, v26, v27
  v_mfma_f32_32x32x16_bf16 v[84:99], v[124:127], v[64:67], v[84:99]
  v_exp_f32 v32, v32
  v_exp_f32 v33, v33
  v_cvt_pk_bf16_f32 v56, v28, v29
  v_exp_f32 v34, v34
  v_exp_f32 v35, v35
  v_cvt_pk_bf16_f32 v57, v30, v31
  v_cvt_pk_bf16_f32 v58, v32, v33
  v_cvt_pk_bf16_f32 v59, v34, v35
  s_waitcnt lgkmcnt(0)
  v_readfirstlane_b32 s55, v7
  s_cmp_lt_u32 s55, 16
  s_cselect_b32 s64, s55, s54
  s_cbranch_scc1 L2_more1
  s_setprio 3
L2_more1:
  s_lshr_b32 s56, s64, 1
  s_mul_i32 s56, s56, 18432
  s_and_b32 s59, s64, 1
  s_lshl_b32 s57, s59, 12
  s_add_u32 s57, s57, s56
  s_lshl_b32 s58, s59, 9
  s_add_u32 s58, s58, s56
  s_mul_i32 s63, s59, 4608
  s_add_u32 s63, s63, s56
  s_lshr_b32 s64, s64, 1
  s_cmp_lt_u32 s64, s61
  s_cbranch_scc1 L2_landed1
  v_mov_b32 v1, 161284
L2_spinL1:
  ds_read_b32 v3, v1
  s_waitcnt lgkmcnt(0)
  v_readfirstlane_b32 s61, v3
  s_cmp_lt_u32 s64, s61
  s_cbranch_scc1 L2_landed1
  s_sleep 1
  s_branch L2_spinL1
L2_landed1:
  v_add_u32 v163, s57, v160
  v_add_u32 v164, s58, v161
  v_mfma_f32_32x32x16_bf16 v[20:35], v[104:107], v[8:11], v[128:143]
  v_exp_f32 v36, v36
  v_exp_f32 v37, v37
  v_exp_f32 v38, v38
  v_exp_f32 v39, v39
  v_mfma_f32_32x32x16_bf16 v[68:83], v[112:115], v[52:55], v[68:83]
  v_exp_f32 v40, v40
  v_exp_f32 v41, v41
  v_cvt_pk_bf16_f32 v60, v36, v37
  v_exp_f32 v42, v42
  v_exp_f32 v43, v43
  v_cvt_pk_bf16_f32 v61, v38, v39
  v_exp_f32 v44, v44
  v_mfma_f32_32x32x8_bf16 v[20:35], v[110:111], v[12:13], v[20:35]
  v_exp_f32 v45, v45
  v_cvt_pk_bf16_f32 v62, v40, v41
  v_exp_f32 v46, v46
  v_exp_f32 v47, v47
  v_cvt_pk_bf16_f32 v63, v42, v43
  v_mfma_f32_32x32x16_bf16 v[68:83], v[116:119], v[56:59], v[68:83]
  v_exp_f32 v48, v48
  v_exp_f32 v49, v49
  v_cvt_pk_bf16_f32 v64, v44, v45
  v_exp_f32 v50, v50
  v_exp_f32 v51, v51
  v_cvt_pk_bf16_f32 v65, v46, v47
  v_cvt_pk_bf16_f32 v66, v48, v49
  v_cvt_pk_bf16_f32 v67, v50, v51
  v_mfma_f32_32x32x16_bf16 v[36:51], v[104:107], v[14:17], v[144:159]
  s_mov_b64 exec, s[52:53]
  ds_read_b128 v[120:123], v165 offset:3456
  ds_read_b128 v[124:127], v165 offset:4032
  s_mov_b64 exec, -1
  v_exp_f32 v20, v20
  v_exp_f32 v21, v21
  v_exp_f32 v22, v22
  v_exp_f32 v23, v23
  v_mfma_f32_32x32x16_bf16 v[84:99], v[112:115], v[60:63], v[84:99]
  v_exp_f32 v24, v24
  v_exp_f32 v25, v25
  v_cvt_pk_bf16_f32 v52, v20, v21
  v_exp_f32 v26, v26
  v_exp_f32 v27, v27
  v_cvt_pk_bf16_f32 v53, v22, v23
  ds_read_b128 v[100:103], v163 offset:0
  ds_read_b32 v108, v164 offset:0
  v_exp_f32 v28, v28
  v_mfma_f32_32x32x8_bf16 v[36:51], v[110:111], v[18:19], v[36:51]
  v_exp_f32 v29, v29
  v_cvt_pk_bf16_f32 v54, v24, v25
  v_exp_f32 v30, v30
  v_exp_f32 v31, v31
  v_cvt_pk_bf16_f32 v55, v26, v27
  v_mfma_f32_32x32x16_bf16 v[84:99], v[116:119], v[64:67], v[84:99]
  v_exp_f32 v32, v32
  v_exp_f32 v33, v33
  v_cvt_pk_bf16_f32 v56, v28, v29
  v_exp_f32 v34, v34
  v_exp_f32 v35, v35
  v_cvt_pk_bf16_f32 v57, v30, v31
  v_cvt_pk_bf16_f32 v58, v32, v33
  v_cvt_pk_bf16_f32 v59, v34, v35
  s_waitcnt lgkmcnt(0)
  v_mfma_f32_32x32x16_bf16 v[20:35], v[100:103], v[8:11], v[128:143]
  v_exp_f32 v36, v36
  v_exp_f32 v37, v37
  v_exp_f32 v38, v38
  v_exp_f32 v39, v39
  v_mfma_f32_32x32x16_bf16 v[68:83], v[120:123], v[52:55], v[68:83]
  v_exp_f32 v40, v40
  v_exp_f32 v41, v41
  v_cvt_pk_bf16_f32 v60, v36, v37
  v_exp_f32 v42, v42
  v_exp_f32 v43, v43
  v_cvt_pk_bf16_f32 v61, v38, v39
  v_exp_f32 v44, v44
  v_mfma_f32_32x32x8_bf16 v[20:35], v[108:109], v[12:13], v[20:35]
  v_exp_f32 v45, v45
  v_cvt_pk_bf16_f32 v62, v40, v41
  v_exp_f32 v46, v46
  v_exp_f32 v47, v47
  v_cvt_pk_bf16_f32 v63, v42, v43
  v_mfma_f32_32x32x16_bf16 v[68:83], v[124:127], v[56:59], v[68:83]
  v_exp_f32 v48, v48
  v_exp_f32 v49, v49
  v_cvt_pk_bf16_f32 v64, v44, v45
  v_exp_f32 v50, v50
  v_exp_f32 v51, v51
  v_cvt_pk_bf16_f32 v65, v46, v47
  v_cvt_pk_bf16_f32 v66, v48, v49
  v_cvt_pk_bf16_f32 v67, v50, v51
  v_add_u32 v165, s63, v162
  s_mov_b32 s54, s55
  s_cmp_lt_u32 s54, 16
  s_cbranch_scc1 L2_stage1
  v_mfma_f32_32x32x16_bf16 v[84:99], v[120:123], v[60:63], v[84:99]
  v_mfma_f32_32x32x16_bf16 v[84:99], v[124:127], v[64:67], v[84:99]
  s_nop 7
  s_nop 3
L2_combine:
  s_barrier
L2_exch:
  s_mul_i32 s55, s45, 6144
  v_lshlrev_b32 v1, 4, v2
  v_add_u32 v1, s55, v1
  s_cmp_eq_u32 s46, 0
  s_cbranch_scc1 L2_recv
  ds_write_b128 v1, v[68:71] offset:0
  ds_write_b128 v1, v[72:75] offset:1024
  ds_write_b128 v1, v[76:79] offset:2048
  ds_write_b128 v1, v[84:87] offset:3072
  ds_write_b128 v1, v[88:91] offset:4096
  ds_write_b128 v1, v[92:95] offset:5120
  s_waitcnt lgkmcnt(0)
  s_barrier
  s_cmp_gt_u32 s42, 5
  s_cbranch_scc1 L2_noC4
  s_lshr_b32 s55, s40, 3
  s_add_u32 s55, s55, 140
  s_cmp_eq_u32 s42, 4
  s_cselect_b32 s55, 144, s55
  s_movk_i32 s56, 144
  s_cselect_b32 s56, 256, s56
  s_lshl_b32 s55, s55, 7
  s_add_u32 s55, s55, 0x14c4000
  v_mov_b32 v8, s55
  v_mov_b32 v9, s56
  s_mov_b32 s57, 200000
Lpoll_15:
  buffer_load_dword v10, v8, s[36:39], 0 offen sc1
  s_waitcnt vmcnt(0)
  v_cmp_lt_u32 vcc, v10, v9
  s_nop 3
  s_cmp_eq_u64 vcc, 0
  s_cbranch_scc1 Lpoll_15_x
  s_sleep 4
  s_sub_u32 s57, s57, 1
  s_cmp_lg_u32 s57, 0
  s_cbranch_scc1 Lpoll_15
Lpoll_15_x:
  v_mov_b32 v8, 161312
  v_mov_b32 v9, 1
  s_mov_b64 exec, 1
  ds_add_u32 v8, v9
  s_mov_b64 exec, -1
  s_waitcnt lgkmcnt(0)
L2_noC4:
  s_barrier
  s_load_dwordx2 s[4:5], s[0:1], 0
  s_load_dwordx2 s[6:7], s[0:1], 80
  s_and_b32 s43, s40, 7
  s_lshl_b32 s43, s43, 5
  s_lshl_b32 s44, s41, 8
  s_add_u32 s43, s43, s44
  s_lshr_b32 s44, s40, 3
  v_and_b32 v3, 15, v2
  v_lshrrev_b32 v4, 4, v2
  v_lshlrev_b32 v5, 4, v2
  v_mov_b32 v1, 161312
Lspin_16:
  ds_read_b32 v6, v1
  s_waitcnt lgkmcnt(0)
  v_readfirstlane_b32 s56, v6
  s_cmp_ge_u32 s56, 2
  s_cbranch_scc1 Lspin_16_x
  s_sleep 1
  s_branch Lspin_16
Lspin_16_x:
  s_mov_b32 s16, s4
  s_and_b32 s17, s5, 0xffff
  s_mov_b32 s18, 0x240000
  s_mov_b32 s19, 0x20000
  s_mov_b32 s20, s6
  s_and_b32 s21, s7, 0xffff
  s_mov_b32 s22, 0x240000
  s_mov_b32 s23, 0x20000
  s_mul_i32 s45, s44, 9
  s_mul_i32 s47, s44, 288
  s_cmp_lt_u32 s42, 6
  s_cbranch_scc1 L3_rY
  s_add_u32 s46, s45, 8
  s_mul_i32 s46, s46, 18*1024
  s_add_u32 s46, s46, 0x1322000
  s_sub_u32 s52, s42, 6
  s_mul_i32 s52, s52, 9216
  s_add_u32 s46, s46, s52
  buffer_load_dwordx4 v[92:95], v5, s[36:39], s46 offen offset:0 sc1
  buffer_load_dwordx4 v[96:99], v5, s[36:39], s46 offen offset:1024 sc1
  buffer_load_dwordx4 v[100:103], v5, s[36:39], s46 offen offset:2048 sc1
  buffer_load_dwordx4 v[104:107], v5, s[36:39], s46 offen offset:3072 sc1
  s_add_u32 s46, s46, 4096
  buffer_load_dwordx4 v[108:111], v5, s[36:39], s46 offen offset:0 sc1
  buffer_load_dwordx4 v[112:115], v5, s[36:39], s46 offen offset:1024 sc1
  buffer_load_dwordx4 v[116:119], v5, s[36:39], s46 offen offset:2048 sc1
  buffer_load_dwordx4 v[120:123], v5, s[36:39], s46 offen offset:3072 sc1
  s_add_u32 s46, s46, 4096
  buffer_load_dwordx4 v[124:127], v5, s[36:39], s46 offen offset:0 sc1
  s_add_u32 s52, s52, 112640
  v_add_u32 v12, s52, v5
  s_branch L3_pf
L3_rY:
  v_lshrrev_b32 v14, 2, v2
  v_and_b32 v15, 3, v2
  s_sub_u32 s52, s42, 4
  s_mul_i32 s52, s52, 80
  s_mul_i32 s53, s44, 144
  s_add_u32 s53, s53, s52
  v_add_u32 v14, s53, v14
  v_lshlrev_b32 v14, 12, v14
  v_lshl_add_u32 v14, v15, 4, v14
  s_lshl_b32 s53, s43, 1
  s_add_u32 s53, s53, 0xea0000
  buffer_load_dwordx4 v[92:95], v14, s[36:39], s53 offen sc1
  s_add_u32 s53, s53, 16*4096
  buffer_load_dwordx4 v[96:99], v14, s[36:39], s53 offen sc1
  s_add_u32 s53, s53, 16*4096
  buffer_load_dwordx4 v[100:103], v14, s[36:39], s53 offen sc1
  s_add_u32 s53, s53, 16*4096
  buffer_load_dwordx4 v[104:107], v14, s[36:39], s53 offen sc1
  s_add_u32 s53, s53, 16*4096
  buffer_load_dwordx4 v[108:111], v14, s[36:39], s53 offen sc1
  s_add_u32 s53, s53, 16*4096
  s_lshl_b32 s52, s52, 6
  s_add_u32 s52, s52, 90112
  v_add_u32 v12, s52, v5
L3_pf:
  v_mov_b32 v1, 161352
Lspin_17:
  ds_read_b32 v6, v1
  s_waitcnt lgkmcnt(0)
  v_readfirstlane_b32 s56, v6
  s_cmp_ge_u32 s56, 1
  s_cbranch_scc1 Lspin_17_x
  s_sleep 1
  s_branch Lspin_17
Lspin_17_x:
  s_mul_i32 s45, s44, 9
  s_add_u32 s46, s45, s42
  s_mul_i32 s46, s46, 18*1024
  s_add_u32 s46, s46, 0x1322000
  buffer_load_dwordx4 v[20:23], v5, s[36:39], s46 offen offset:0 sc1
  buffer_load_dwordx4 v[24:27], v5, s[36:39], s46 offen offset:1024 sc1
  buffer_load_dwordx4 v[28:31], v5, s[36:39], s46 offen offset:2048 sc1
  buffer_load_dwordx4 v[32:35], v5, s[36:39], s46 offen offset:3072 sc1
  s_add_u32 s46, s46, 4096
  buffer_load_dwordx4 v[36:39], v5, s[36:39], s46 offen offset:0 sc1
  buffer_load_dwordx4 v[40:43], v5, s[36:39], s46 offen offset:1024 sc1
  buffer_load_dwordx4 v[44:47], v5, s[36:39], s46 offen offset:2048 sc1
  buffer_load_dwordx4 v[48:51], v5, s[36:39], s46 offen offset:3072 sc1
  s_add_u32 s46, s46, 4096
  buffer_load_dwordx4 v[52:55], v5, s[36:39], s46 offen offset:0 sc1
  buffer_load_dwordx4 v[56:59], v5, s[36:39], s46 offen offset:1024 sc1
  buffer_load_dwordx4 v[60:63], v5, s[36:39], s46 offen offset:2048 sc1
  buffer_load_dwordx4 v[64:67], v5, s[36:39], s46 offen offset:3072 sc1
  s_add_u32 s46, s46, 4096
  buffer_load_dwordx4 v[68:71], v5, s[36:39], s46 offen offset:0 sc1
  buffer_load_dwordx4 v[72:75], v5, s[36:39], s46 offen offset:1024 sc1
  buffer_load_dwordx4 v[76:79], v5, s[36:39], s46 offen offset:2048 sc1
  buffer_load_dwordx4 v[80:83], v5, s[36:39], s46 offen offset:3072 sc1
  s_add_u32 s46, s46, 4096
  buffer_load_dwordx4 v[84:87], v5, s[36:39], s46 offen offset:0 sc1
  buffer_load_dwordx4 v[88:91], v5, s[36:39], s46 offen offset:1024 sc1
  v_add_u32 v6, s43, v3
  v_lshlrev_b32 v14, 2, v6
  s_mov_b32 s51, 0x1320000
  buffer_load_dword v16, v14, s[36:39], s51 offen sc1
  buffer_load_dword v17, v14, s[36:39], s51 offen offset:64 sc1
  s_branch L2_p3
L2_recv:
  s_barrier
  ds_read_b128 v[20:23], v1 offset:0
  ds_read_b128 v[24:27], v1 offset:1024
  ds_read_b128 v[28:31], v1 offset:2048
  ds_read_b128 v[32:35], v1 offset:3072
  ds_read_b128 v[36:39], v1 offset:4096
  ds_read_b128 v[40:43], v1 offset:5120
  s_waitcnt lgkmcnt(0)
  v_add_f32 v68, v68, v20
  v_add_f32 v69, v69, v21
  v_add_f32 v70, v70, v22
  v_add_f32 v71, v71, v23
  v_add_f32 v72, v72, v24
  v_add_f32 v73, v73, v25
  v_add_f32 v74, v74, v26
  v_add_f32 v75, v75, v27
  v_add_f32 v76, v76, v28
  v_add_f32 v77, v77, v29
  v_add_f32 v78, v78, v30
  v_add_f32 v79, v79, v31
  v_add_f32 v84, v84, v32
  v_add_f32 v85, v85, v33
  v_add_f32 v86, v86, v34
  v_add_f32 v87, v87, v35
  v_add_f32 v88, v88, v36
  v_add_f32 v89, v89, v37
  v_add_f32 v90, v90, v38
  v_add_f32 v91, v91, v39
  v_add_f32 v92, v92, v40
  v_add_f32 v93, v93, v41
  v_add_f32 v94, v94, v42
  v_add_f32 v95, v95, v43
  v_mov_b32 v52, v78
  v_mov_b32 v53, v78
  v_mov_b32 v54, v94
  v_mov_b32 v55, v94
  s_nop 1
  v_permlane32_swap_b32 v52, v53
  v_permlane32_swap_b32 v54, v55
  s_nop 1
  v_rcp_f32 v52, v52
  v_rcp_f32 v54, v54
  s_lshl_b32 s55, s45, 6
  v_add_u32 v3, s55, v4
  v_mul_u32_u24 v3, 36, v3
  v_lshl_add_u32 v3, v5, 3, v3
  v_add_u32 v3, 32768, v3
  v_cmp_eq_u32 vcc, 0, v5
  v_mul_f32 v68, v68, v52
  v_mul_f32 v69, v69, v52
  v_mul_f32 v70, v70, v52
  v_mul_f32 v71, v71, v52
  v_mul_f32 v72, v72, v52
  v_mul_f32 v73, v73, v52
  v_mul_f32 v74, v74, v52
  v_mul_f32 v75, v75, v52
  v_mul_f32 v76, v76, v52
  v_mul_f32 v77, v77, v52
  v_cvt_pk_bf16_f32 v56, v68, v69
  v_cvt_pk_bf16_f32 v57, v70, v71
  v_cvt_pk_bf16_f32 v58, v72, v73
  v_cvt_pk_bf16_f32 v59, v74, v75
  v_cvt_pk_bf16_f32 v60, v76, v77
  v_mul_f32 v84, v84, v54
  v_mul_f32 v85, v85, v54
  v_mul_f32 v86, v86, v54
  v_mul_f32 v87, v87, v54
  v_mul_f32 v88, v88, v54
  v_mul_f32 v89, v89, v54
  v_mul_f32 v90, v90, v54
  v_mul_f32 v91, v91, v54
  v_mul_f32 v92, v92, v54
  v_mul_f32 v93, v93, v54
  v_cvt_pk_bf16_f32 v61, v84, v85
  v_cvt_pk_bf16_f32 v62, v86, v87
  v_cvt_pk_bf16_f32 v63, v88, v89
  v_cvt_pk_bf16_f32 v64, v90, v91
  v_cvt_pk_bf16_f32 v65, v92, v93
  ds_write_b32 v3, v56 offset:0
  ds_write_b32 v3, v57 offset:4
  ds_write_b32 v3, v58 offset:16
  ds_write_b32 v3, v59 offset:20
  ds_write_b32 v3, v61 offset:1152
  ds_write_b32 v3, v62 offset:1156
  ds_write_b32 v3, v63 offset:1168
  ds_write_b32 v3, v64 offset:1172
  s_and_saveexec_b64 s[56:57], vcc
  ds_write_b32 v3, v60 offset:32
  ds_write_b32 v3, v65 offset:1184
  s_mov_b64 exec, s[56:57]
  s_waitcnt lgkmcnt(0)
  s_barrier
  s_lshl_b32 s55, s42, 10
  v_lshlrev_b32 v1, 4, v2
  v_add_u32 v1, s55, v1
  v_add_u32 v3, 32768, v1
  ds_read_b128 v[8:11], v3
  ds_read_b128 v[12:15], v3 offset:4096
  s_mul_i32 s57, s40, 73728
  s_mul_i32 s58, s41, 9216
  s_add_u32 s57, s57, s58
  s_add_u32 s57, s57, 0x10e0000
  v_add_u32 v6, 4096, v1
  s_cmp_lg_u32 s42, 0
  s_cbranch_scc1 L2_o1
  ds_read_b128 v[16:19], v3 offset:8192
  s_waitcnt lgkmcnt(0)
  v_add_u32 v7, 8192, v1
  buffer_store_dwordx4 v[16:19], v7, s[36:39], s57 offen sc1
L2_o1:
  s_waitcnt lgkmcnt(0)
  buffer_store_dwordx4 v[8:11], v1, s[36:39], s57 offen sc1
  buffer_store_dwordx4 v[12:15], v6, s[36:39], s57 offen sc1
  s_waitcnt vmcnt(0)
  v_mov_b32 v1, 161348
  v_mov_b32 v3, 1
  s_mov_b64 exec, 1
  ds_add_u32 v1, v3
  s_mov_b64 exec, -1
L2_p3:
  s_setprio 0
  s_cmp_ge_u32 s42, 4
  s_cbranch_scc1 L3_calc
  s_cmp_lg_u32 s42, 0
  s_cbranch_scc1 L3_noarr
  v_mov_b32 v1, 161348
Lspin_18:
  ds_read_b32 v3, v1
  s_waitcnt lgkmcnt(0)
  v_readfirstlane_b32 s56, v3
  s_cmp_ge_u32 s56, 4
  s_cbranch_scc1 Lspin_18_x
  s_sleep 1
  s_branch Lspin_18
Lspin_18_x:
  s_add_u32 s52, s41, 145
  s_lshl_b32 s57, s52, 7
  s_add_u32 s57, s57, 0x14c4000
  v_mov_b32 v14, s57
  v_mov_b32 v15, 1
  s_mov_b64 exec, 1
  buffer_atomic_add v15, v14, s[36:39], 0 offen sc1
  s_mov_b64 exec, -1
  v_mov_b32 v1, 161352
  v_mov_b32 v3, 1
  ds_write_b32 v1, v3
  s_waitcnt lgkmcnt(0)
L3_noarr:
  s_load_dwordx2 s[4:5], s[0:1], 0
  s_load_dwordx2 s[6:7], s[0:1], 80
  s_and_b32 s43, s40, 7
  s_lshl_b32 s43, s43, 5
  s_lshl_b32 s44, s41, 8
  s_add_u32 s43, s43, s44
  s_lshr_b32 s44, s40, 3
  v_and_b32 v3, 15, v2
  v_lshrrev_b32 v4, 4, v2
  v_lshlrev_b32 v5, 4, v2
  v_mov_b32 v1, 161312
Lspin_19:
  ds_read_b32 v6, v1
  s_waitcnt lgkmcnt(0)
  v_readfirstlane_b32 s56, v6
  s_cmp_ge_u32 s56, 2
  s_cbranch_scc1 Lspin_19_x
  s_sleep 1
  s_branch Lspin_19
Lspin_19_x:
  s_mov_b32 s16, s4
  s_and_b32 s17, s5, 0xffff
  s_mov_b32 s18, 0x240000
  s_mov_b32 s19, 0x20000
  s_mov_b32 s20, s6
  s_and_b32 s21, s7, 0xffff
  s_mov_b32 s22, 0x240000
  s_mov_b32 s23, 0x20000
  s_mul_i32 s45, s44, 9
  s_mul_i32 s47, s44, 288
  s_cmp_eq_u32 s42, 0
  s_cbranch_scc1 L3_calc
  s_movk_i32 s52, 3641
  s_sub_u32 s53, s42, 1
  s_mul_i32 s53, s53, 192
  v_add_u32 v8, s53, v2
  v_add_u32 v8, 0, v8
  v_mul_u32_u24 v9, s52, v8
  v_lshrrev_b32 v9, 16, v9
  v_mul_u32_u24 v10, 18, v9
  v_sub_u32 v10, v8, v10
  v_mul_u32_u24 v11, 304, v9
  v_lshl_add_u32 v160, v10, 4, v11
  v_add_u32 v160, 131072, v160
  v_add_u32 v9, s43, v9
  v_mul_u32_u24 v9, 1152, v9
  v_lshl_add_u32 v9, v10, 4, v9
  buffer_load_dwordx4 v[92:95], v9, s[16:19], s47 offen
  v_add_u32 v8, s53, v2
  v_add_u32 v8, 64, v8
  v_mul_u32_u24 v9, s52, v8
  v_lshrrev_b32 v9, 16, v9
  v_mul_u32_u24 v10, 18, v9
  v_sub_u32 v10, v8, v10
  v_mul_u32_u24 v11, 304, v9
  v_lshl_add_u32 v161, v10, 4, v11
  v_add_u32 v161, 131072, v161
  v_add_u32 v9, s43, v9
  v_mul_u32_u24 v9, 1152, v9
  v_lshl_add_u32 v9, v10, 4, v9
  buffer_load_dwordx4 v[96:99], v9, s[16:19], s47 offen
  v_add_u32 v8, s53, v2
  v_add_u32 v8, 128, v8
  v_mul_u32_u24 v9, s52, v8
  v_lshrrev_b32 v9, 16, v9
  v_mul_u32_u24 v10, 18, v9
  v_sub_u32 v10, v8, v10
  v_mul_u32_u24 v11, 304, v9
  v_lshl_add_u32 v162, v10, 4, v11
  v_add_u32 v162, 131072, v162
  v_add_u32 v9, s43, v9
  v_mul_u32_u24 v9, 1152, v9
  v_lshl_add_u32 v9, v10, 4, v9
  buffer_load_dwordx4 v[100:103], v9, s[16:19], s47 offen
  v_mov_b32 v1, 161352
Lspin_20:
  ds_read_b32 v6, v1
  s_waitcnt lgkmcnt(0)
  v_readfirstlane_b32 s56, v6
  s_cmp_ge_u32 s56, 1
  s_cbranch_scc1 Lspin_20_x
  s_sleep 1
  s_branch Lspin_20
Lspin_20_x:
  s_mul_i32 s45, s44, 9
  s_add_u32 s46, s45, s42
  s_mul_i32 s46, s46, 18*1024
  s_add_u32 s46, s46, 0x1322000
  buffer_load_dwordx4 v[20:23], v5, s[36:39], s46 offen offset:0 sc1
  buffer_load_dwordx4 v[24:27], v5, s[36:39], s46 offen offset:1024 sc1
  buffer_load_dwordx4 v[28:31], v5, s[36:39], s46 offen offset:2048 sc1
  buffer_load_dwordx4 v[32:35], v5, s[36:39], s46 offen offset:3072 sc1
  s_add_u32 s46, s46, 4096
  buffer_load_dwordx4 v[36:39], v5, s[36:39], s46 offen offset:0 sc1
  buffer_load_dwordx4 v[40:43], v5, s[36:39], s46 offen offset:1024 sc1
  buffer_load_dwordx4 v[44:47], v5, s[36:39], s46 offen offset:2048 sc1
  buffer_load_dwordx4 v[48:51], v5, s[36:39], s46 offen offset:3072 sc1
  s_add_u32 s46, s46, 4096
  buffer_load_dwordx4 v[52:55], v5, s[36:39], s46 offen offset:0 sc1
  buffer_load_dwordx4 v[56:59], v5, s[36:39], s46 offen offset:1024 sc1
  buffer_load_dwordx4 v[60:63], v5, s[36:39], s46 offen offset:2048 sc1
  buffer_load_dwordx4 v[64:67], v5, s[36:39], s46 offen offset:3072 sc1
  s_add_u32 s46, s46, 4096
  buffer_load_dwordx4 v[68:71], v5, s[36:39], s46 offen offset:0 sc1
  buffer_load_dwordx4 v[72:75], v5, s[36:39], s46 offen offset:1024 sc1
  buffer_load_dwordx4 v[76:79], v5, s[36:39], s46 offen offset:2048 sc1
  buffer_load_dwordx4 v[80:83], v5, s[36:39], s46 offen offset:3072 sc1
  s_add_u32 s46, s46, 4096
  buffer_load_dwordx4 v[84:87], v5, s[36:39], s46 offen offset:0 sc1
  buffer_load_dwordx4 v[88:91], v5, s[36:39], s46 offen offset:1024 sc1
  v_add_u32 v6, s43, v3
  v_lshlrev_b32 v14, 2, v6
  s_mov_b32 s51, 0x1320000
  buffer_load_dword v16, v14, s[36:39], s51 offen sc1
  buffer_load_dword v17, v14, s[36:39], s51 offen offset:64 sc1
L3_calc:
  s_movk_i32 s52, 7282
  s_mul_i32 s54, s42, 36
  v_lshlrev_b32 v14, 2, v2
  v_add_u32 v14, 0, v14
  v_mul_u32_u24 v15, s52, v14
  v_lshrrev_b32 v15, 16, v15
  v_mul_u32_u24 v18, 9, v15
  v_sub_u32 v14, v14, v18
  v_add_u32 v14, s54, v14
  v_bfe_u32 v18, v15, 1, 3
  v_mul_u32_u24 v15, 1152, v15
  v_add_u32 v15, 49152, v15
  v_lshrrev_b32 v164, 2, v14
  v_xor_b32 v164, v164, v18
  v_lshl_add_u32 v164, v164, 4, v15
  v_and_b32 v165, 3, v14
  v_lshl_add_u32 v128, v165, 2, v164
  v_add_u32 v14, 9, v14
  v_lshrrev_b32 v164, 2, v14
  v_xor_b32 v164, v164, v18
  v_lshl_add_u32 v164, v164, 4, v15
  v_and_b32 v165, 3, v14
  v_lshl_add_u32 v136, v165, 2, v164
  v_add_u32 v14, 9, v14
  v_lshrrev_b32 v164, 2, v14
  v_xor_b32 v164, v164, v18
  v_lshl_add_u32 v164, v164, 4, v15
  v_and_b32 v165, 3, v14
  v_lshl_add_u32 v144, v165, 2, v164
  v_add_u32 v14, 9, v14
  v_lshrrev_b32 v164, 2, v14
  v_xor_b32 v164, v164, v18
  v_lshl_add_u32 v164, v164, 4, v15
  v_and_b32 v165, 3, v14
  v_lshl_add_u32 v152, v165, 2, v164
  v_lshlrev_b32 v14, 2, v2
  v_add_u32 v14, 1, v14
  v_mul_u32_u24 v15, s52, v14
  v_lshrrev_b32 v15, 16, v15
  v_mul_u32_u24 v18, 9, v15
  v_sub_u32 v14, v14, v18
  v_add_u32 v14, s54, v14
  v_bfe_u32 v18, v15, 1, 3
  v_mul_u32_u24 v15, 1152, v15
  v_add_u32 v15, 49152, v15
  v_lshrrev_b32 v164, 2, v14
  v_xor_b32 v164, v164, v18
  v_lshl_add_u32 v164, v164, 4, v15
  v_and_b32 v165, 3, v14
  v_lshl_add_u32 v129, v165, 2, v164
  v_add_u32 v14, 9, v14
  v_lshrrev_b32 v164, 2, v14
  v_xor_b32 v164, v164, v18
  v_lshl_add_u32 v164, v164, 4, v15
  v_and_b32 v165, 3, v14
  v_lshl_add_u32 v137, v165, 2, v164
  v_add_u32 v14, 9, v14
  v_lshrrev_b32 v164, 2, v14
  v_xor_b32 v164, v164, v18
  v_lshl_add_u32 v164, v164, 4, v15
  v_and_b32 v165, 3, v14
  v_lshl_add_u32 v145, v165, 2, v164
  v_add_u32 v14, 9, v14
  v_lshrrev_b32 v164, 2, v14
  v_xor_b32 v164, v164, v18
  v_lshl_add_u32 v164, v164, 4, v15
  v_and_b32 v165, 3, v14
  v_lshl_add_u32 v153, v165, 2, v164
  v_lshlrev_b32 v14, 2, v2
  v_add_u32 v14, 2, v14
  v_mul_u32_u24 v15, s52, v14
  v_lshrrev_b32 v15, 16, v15
  v_mul_u32_u24 v18, 9, v15
  v_sub_u32 v14, v14, v18
  v_add_u32 v14, s54, v14
  v_bfe_u32 v18, v15, 1, 3
  v_mul_u32_u24 v15, 1152, v15
  v_add_u32 v15, 49152, v15
  v_lshrrev_b32 v164, 2, v14
  v_xor_b32 v164, v164, v18
  v_lshl_add_u32 v164, v164, 4, v15
  v_and_b32 v165, 3, v14
  v_lshl_add_u32 v130, v165, 2, v164
  v_add_u32 v14, 9, v14
  v_lshrrev_b32 v164, 2, v14
  v_xor_b32 v164, v164, v18
  v_lshl_add_u32 v164, v164, 4, v15
  v_and_b32 v165, 3, v14
  v_lshl_add_u32 v138, v165, 2, v164
  v_add_u32 v14, 9, v14
  v_lshrrev_b32 v164, 2, v14
  v_xor_b32 v164, v164, v18
  v_lshl_add_u32 v164, v164, 4, v15
  v_and_b32 v165, 3, v14
  v_lshl_add_u32 v146, v165, 2, v164
  v_add_u32 v14, 9, v14
  v_lshrrev_b32 v164, 2, v14
  v_xor_b32 v164, v164, v18
  v_lshl_add_u32 v164, v164, 4, v15
  v_and_b32 v165, 3, v14
  v_lshl_add_u32 v154, v165, 2, v164
  v_lshlrev_b32 v14, 2, v2
  v_add_u32 v14, 3, v14
  v_mul_u32_u24 v15, s52, v14
  v_lshrrev_b32 v15, 16, v15
  v_mul_u32_u24 v18, 9, v15
  v_sub_u32 v14, v14, v18
  v_add_u32 v14, s54, v14
  v_bfe_u32 v18, v15, 1, 3
  v_mul_u32_u24 v15, 1152, v15
  v_add_u32 v15, 49152, v15
  v_lshrrev_b32 v164, 2, v14
  v_xor_b32 v164, v164, v18
  v_lshl_add_u32 v164, v164, 4, v15
  v_and_b32 v165, 3, v14
  v_lshl_add_u32 v131, v165, 2, v164
  v_add_u32 v14, 9, v14
  v_lshrrev_b32 v164, 2, v14
  v_xor_b32 v164, v164, v18
  v_lshl_add_u32 v164, v164, 4, v15
  v_and_b32 v165, 3, v14
  v_lshl_add_u32 v139, v165, 2, v164
  v_add_u32 v14, 9, v14
  v_lshrrev_b32 v164, 2, v14
  v_xor_b32 v164, v164, v18
  v_lshl_add_u32 v164, v164, 4, v15
  v_and_b32 v165, 3, v14
  v_lshl_add_u32 v147, v165, 2, v164
  v_add_u32 v14, 9, v14
  v_lshrrev_b32 v164, 2, v14
  v_xor_b32 v164, v164, v18
  v_lshl_add_u32 v164, v164, 4, v15
  v_and_b32 v165, 3, v14
  v_lshl_add_u32 v155, v165, 2, v164
  v_lshlrev_b32 v14, 2, v2
  v_add_u32 v14, 256, v14
  v_mul_u32_u24 v15, s52, v14
  v_lshrrev_b32 v15, 16, v15
  v_mul_u32_u24 v18, 9, v15
  v_sub_u32 v14, v14, v18
  v_add_u32 v14, s54, v14
  v_bfe_u32 v18, v15, 1, 3
  v_mul_u32_u24 v15, 1152, v15
  v_add_u32 v15, 49152, v15
  v_lshrrev_b32 v164, 2, v14
  v_xor_b32 v164, v164, v18
  v_lshl_add_u32 v164, v164, 4, v15
  v_and_b32 v165, 3, v14
  v_lshl_add_u32 v132, v165, 2, v164
  v_add_u32 v14, 9, v14
  v_lshrrev_b32 v164, 2, v14
  v_xor_b32 v164, v164, v18
  v_lshl_add_u32 v164, v164, 4, v15
  v_and_b32 v165, 3, v14
  v_lshl_add_u32 v140, v165, 2, v164
  v_add_u32 v14, 9, v14
  v_lshrrev_b32 v164, 2, v14
  v_xor_b32 v164, v164, v18
  v_lshl_add_u32 v164, v164, 4, v15
  v_and_b32 v165, 3, v14
  v_lshl_add_u32 v148, v165, 2, v164
  v_add_u32 v14, 9, v14
  v_lshrrev_b32 v164, 2, v14
  v_xor_b32 v164, v164, v18
  v_lshl_add_u32 v164, v164, 4, v15
  v_and_b32 v165, 3, v14
  v_lshl_add_u32 v156, v165, 2, v164
  v_lshlrev_b32 v14, 2, v2
  v_add_u32 v14, 257, v14
  v_mul_u32_u24 v15, s52, v14
  v_lshrrev_b32 v15, 16, v15
  v_mul_u32_u24 v18, 9, v15
  v_sub_u32 v14, v14, v18
  v_add_u32 v14, s54, v14
  v_bfe_u32 v18, v15, 1, 3
  v_mul_u32_u24 v15, 1152, v15
  v_add_u32 v15, 49152, v15
  v_lshrrev_b32 v164, 2, v14
  v_xor_b32 v164, v164, v18
  v_lshl_add_u32 v164, v164, 4, v15
  v_and_b32 v165, 3, v14
  v_lshl_add_u32 v133, v165, 2, v164
  v_add_u32 v14, 9, v14
  v_lshrrev_b32 v164, 2, v14
  v_xor_b32 v164, v164, v18
  v_lshl_add_u32 v164, v164, 4, v15
  v_and_b32 v165, 3, v14
  v_lshl_add_u32 v141, v165, 2, v164
  v_add_u32 v14, 9, v14
  v_lshrrev_b32 v164, 2, v14
  v_xor_b32 v164, v164, v18
  v_lshl_add_u32 v164, v164, 4, v15
  v_and_b32 v165, 3, v14
  v_lshl_add_u32 v149, v165, 2, v164
  v_add_u32 v14, 9, v14
  v_lshrrev_b32 v164, 2, v14
  v_xor_b32 v164, v164, v18
  v_lshl_add_u32 v164, v164, 4, v15
  v_and_b32 v165, 3, v14
  v_lshl_add_u32 v157, v165, 2, v164
  v_lshlrev_b32 v14, 2, v2
  v_add_u32 v14, 258, v14
  v_mul_u32_u24 v15, s52, v14
  v_lshrrev_b32 v15, 16, v15
  v_mul_u32_u24 v18, 9, v15
  v_sub_u32 v14, v14, v18
  v_add_u32 v14, s54, v14
  v_bfe_u32 v18, v15, 1, 3
  v_mul_u32_u24 v15, 1152, v15
  v_add_u32 v15, 49152, v15
  v_lshrrev_b32 v164, 2, v14
  v_xor_b32 v164, v164, v18
  v_lshl_add_u32 v164, v164, 4, v15
  v_and_b32 v165, 3, v14
  v_lshl_add_u32 v134, v165, 2, v164
  v_add_u32 v14, 9, v14
  v_lshrrev_b32 v164, 2, v14
  v_xor_b32 v164, v164, v18
  v_lshl_add_u32 v164, v164, 4, v15
  v_and_b32 v165, 3, v14
  v_lshl_add_u32 v142, v165, 2, v164
  v_add_u32 v14, 9, v14
  v_lshrrev_b32 v164, 2, v14
  v_xor_b32 v164, v164, v18
  v_lshl_add_u32 v164, v164, 4, v15
  v_and_b32 v165, 3, v14
  v_lshl_add_u32 v150, v165, 2, v164
  v_add_u32 v14, 9, v14
  v_lshrrev_b32 v164, 2, v14
  v_xor_b32 v164, v164, v18
  v_lshl_add_u32 v164, v164, 4, v15
  v_and_b32 v165, 3, v14
  v_lshl_add_u32 v158, v165, 2, v164
  v_lshlrev_b32 v14, 2, v2
  v_add_u32 v14, 259, v14
  v_mul_u32_u24 v15, s52, v14
  v_lshrrev_b32 v15, 16, v15
  v_mul_u32_u24 v18, 9, v15
  v_sub_u32 v14, v14, v18
  v_add_u32 v14, s54, v14
  v_bfe_u32 v18, v15, 1, 3
  v_mul_u32_u24 v15, 1152, v15
  v_add_u32 v15, 49152, v15
  v_lshrrev_b32 v164, 2, v14
  v_xor_b32 v164, v164, v18
  v_lshl_add_u32 v164, v164, 4, v15
  v_and_b32 v165, 3, v14
  v_lshl_add_u32 v135, v165, 2, v164
  v_add_u32 v14, 9, v14
  v_lshrrev_b32 v164, 2, v14
  v_xor_b32 v164, v164, v18
  v_lshl_add_u32 v164, v164, 4, v15
  v_and_b32 v165, 3, v14
  v_lshl_add_u32 v143, v165, 2, v164
  v_add_u32 v14, 9, v14
  v_lshrrev_b32 v164, 2, v14
  v_xor_b32 v164, v164, v18
  v_lshl_add_u32 v164, v164, 4, v15
  v_and_b32 v165, 3, v14
  v_lshl_add_u32 v151, v165, 2, v164
  v_add_u32 v14, 9, v14
  v_lshrrev_b32 v164, 2, v14
  v_xor_b32 v164, v164, v18
  v_lshl_add_u32 v164, v164, 4, v15
  v_and_b32 v165, 3, v14
  v_lshl_add_u32 v159, v165, 2, v164
  s_lshl_b32 s52, s42, 2
  s_mul_i32 s53, s52, 73728
  s_mul_i32 s54, s43, 36
  s_add_u32 s53, s53, s54
  s_add_u32 s53, s53, 0x10e0000
  v_add_u32 v14, 1024, v5
  v_mov_b32 v15, 0x80000000
  v_cmp_gt_u32 vcc, 8, v2
  s_nop 1
  v_cndmask_b32 v19, v15, v14, vcc
  s_cmp_eq_u32 s42, 0
  s_cbranch_scc1 L3_prepdone
  s_cmp_lt_u32 s42, 4
  s_cbranch_scc0 L3_s47
  s_waitcnt vmcnt(22)
  ds_write_b128 v160, v[92:95]
  s_waitcnt vmcnt(21)
  ds_write_b128 v161, v[96:99]
  s_waitcnt vmcnt(20)
  ds_write_b128 v162, v[100:103]
  s_branch L3_prepdone
L3_s47:
  s_cmp_lt_u32 s42, 6
  s_cbranch_scc1 L3_sY
  s_waitcnt vmcnt(28)
  ds_write_b128 v12, v[92:95] offset:0
  s_waitcnt vmcnt(27)
  ds_write_b128 v12, v[96:99] offset:1024
  s_waitcnt vmcnt(26)
  ds_write_b128 v12, v[100:103] offset:2048
  s_waitcnt vmcnt(25)
  ds_write_b128 v12, v[104:107] offset:3072
  s_waitcnt vmcnt(24)
  ds_write_b128 v12, v[108:111] offset:4096
  s_waitcnt vmcnt(23)
  ds_write_b128 v12, v[112:115] offset:5120
  s_waitcnt vmcnt(22)
  ds_write_b128 v12, v[116:119] offset:6144
  s_waitcnt vmcnt(21)
  ds_write_b128 v12, v[120:123] offset:7168
  s_waitcnt vmcnt(20)
  ds_write_b128 v12, v[124:127] offset:8192
  s_branch L3_prepdone
L3_sY:
  s_waitcnt vmcnt(24)
  ds_write_b128 v12, v[92:95] offset:0
  s_waitcnt vmcnt(23)
  ds_write_b128 v12, v[96:99] offset:1024
  s_waitcnt vmcnt(22)
  ds_write_b128 v12, v[100:103] offset:2048
  s_waitcnt vmcnt(21)
  ds_write_b128 v12, v[104:107] offset:3072
  s_waitcnt vmcnt(20)
  ds_write_b128 v12, v[108:111] offset:4096
L3_prepdone:
  s_cmp_lg_u32 s42, 0
  s_cbranch_scc1 L3_waitgo
  s_add_u32 s52, s41, 145
  s_lshl_b32 s52, s52, 7
  s_add_u32 s52, s52, 0x14c4000
  v_mov_b32 v14, s52
  v_mov_b32 v15, 32
  s_mov_b32 s57, 200000
Lpoll_21:
  buffer_load_dword v18, v14, s[36:39], 0 offen sc1
  s_waitcnt vmcnt(0)
  v_cmp_lt_u32 vcc, v18, v15
  s_nop 3
  s_cmp_eq_u64 vcc, 0
  s_cbranch_scc1 Lpoll_21_x
  s_sleep 4
  s_sub_u32 s57, s57, 1
  s_cmp_lg_u32 s57, 0
  s_cbranch_scc1 Lpoll_21
Lpoll_21_x:
  v_mov_b32 v1, 161316
  v_mov_b32 v18, 1
  ds_write_b32 v1, v18
  s_waitcnt lgkmcnt(0)
  s_branch L3_go
L3_waitgo:
  v_mov_b32 v1, 161316
Lspin_22:
  ds_read_b32 v18, v1
  s_waitcnt lgkmcnt(0)
  v_readfirstlane_b32 s56, v18
  s_cmp_ge_u32 s56, 1
  s_cbranch_scc1 Lspin_22_x
  s_sleep 1
  s_branch Lspin_22
Lspin_22_x:
L3_go:
  buffer_load_dwordx4 v[92:95], v5, s[36:39], s53 offen sc1
  buffer_load_dwordx4 v[96:99], v19, s[36:39], s53 offen sc1
  s_add_u32 s53, s53, 73728
  buffer_load_dwordx4 v[100:103], v5, s[36:39], s53 offen sc1
  buffer_load_dwordx4 v[104:107], v19, s[36:39], s53 offen sc1
  s_add_u32 s53, s53, 73728
  buffer_load_dwordx4 v[108:111], v5, s[36:39], s53 offen sc1
  buffer_load_dwordx4 v[112:115], v19, s[36:39], s53 offen sc1
  s_add_u32 s53, s53, 73728
  buffer_load_dwordx4 v[116:119], v5, s[36:39], s53 offen sc1
  buffer_load_dwordx4 v[120:123], v19, s[36:39], s53 offen sc1
  s_add_u32 s53, s53, 73728
  s_cmp_lg_u32 s42, 0
  s_cbranch_scc1 L3_w17
  s_mul_i32 s45, s44, 9
  s_add_u32 s46, s45, s42
  s_mul_i32 s46, s46, 18*1024
  s_add_u32 s46, s46, 0x1322000
  buffer_load_dwordx4 v[20:23], v5, s[36:39], s46 offen offset:0 sc1
  buffer_load_dwordx4 v[24:27], v5, s[36:39], s46 offen offset:1024 sc1
  buffer_load_dwordx4 v[28:31], v5, s[36:39], s46 offen offset:2048 sc1
  buffer_load_dwordx4 v[32:35], v5, s[36:39], s46 offen offset:3072 sc1
  s_add_u32 s46, s46, 4096
  buffer_load_dwordx4 v[36:39], v5, s[36:39], s46 offen offset:0 sc1
  buffer_load_dwordx4 v[40:43], v5, s[36:39], s46 offen offset:1024 sc1
  buffer_load_dwordx4 v[44:47], v5, s[36:39], s46 offen offset:2048 sc1
  buffer_load_dwordx4 v[48:51], v5, s[36:39], s46 offen offset:3072 sc1
  s_add_u32 s46, s46, 4096
  buffer_load_dwordx4 v[52:55], v5, s[36:39], s46 offen offset:0 sc1
  buffer_load_dwordx4 v[56:59], v5, s[36:39], s46 offen offset:1024 sc1
  buffer_load_dwordx4 v[60:63], v5, s[36:39], s46 offen offset:2048 sc1
  buffer_load_dwordx4 v[64:67], v5, s[36:39], s46 offen offset:3072 sc1
  s_add_u32 s46, s46, 4096
  buffer_load_dwordx4 v[68:71], v5, s[36:39], s46 offen offset:0 sc1
  buffer_load_dwordx4 v[72:75], v5, s[36:39], s46 offen offset:1024 sc1
  buffer_load_dwordx4 v[76:79], v5, s[36:39], s46 offen offset:2048 sc1
  buffer_load_dwordx4 v[80:83], v5, s[36:39], s46 offen offset:3072 sc1
  s_add_u32 s46, s46, 4096
  buffer_load_dwordx4 v[84:87], v5, s[36:39], s46 offen offset:0 sc1
  buffer_load_dwordx4 v[88:91], v5, s[36:39], s46 offen offset:1024 sc1
  v_add_u32 v6, s43, v3
  v_lshlrev_b32 v14, 2, v6
  s_mov_b32 s51, 0x1320000
  buffer_load_dword v16, v14, s[36:39], s51 offen sc1
  buffer_load_dword v17, v14, s[36:39], s51 offen offset:64 sc1
  s_waitcnt vmcnt(27)
  ds_write_b32 v128, v92
  ds_write_b32 v129, v93
  ds_write_b32 v130, v94
  ds_write_b32 v131, v95
  s_waitcnt vmcnt(26)
  s_mov_b64 exec, 0xff
  ds_write_b32 v132, v96
  ds_write_b32 v133, v97
  ds_write_b32 v134, v98
  ds_write_b32 v135, v99
  s_mov_b64 exec, -1
  s_waitcnt vmcnt(25)
  ds_write_b32 v136, v100
  ds_write_b32 v137, v101
  ds_write_b32 v138, v102
  ds_write_b32 v139, v103
  s_waitcnt vmcnt(24)
  s_mov_b64 exec, 0xff
  ds_write_b32 v140, v104
  ds_write_b32 v141, v105
  ds_write_b32 v142, v106
  ds_write_b32 v143, v107
  s_mov_b64 exec, -1
  s_waitcnt vmcnt(23)
  ds_write_b32 v144, v108
  ds_write_b32 v145, v109
  ds_write_b32 v146, v110
  ds_write_b32 v147, v111
  s_waitcnt vmcnt(22)
  s_mov_b64 exec, 0xff
  ds_write_b32 v148, v112
  ds_write_b32 v149, v113
  ds_write_b32 v150, v114
  ds_write_b32 v151, v115
  s_mov_b64 exec, -1
  s_waitcnt vmcnt(21)
  ds_write_b32 v152, v116
  ds_write_b32 v153, v117
  ds_write_b32 v154, v118
  ds_write_b32 v155, v119
  s_waitcnt vmcnt(20)
  s_mov_b64 exec, 0xff
  ds_write_b32 v156, v120
  ds_write_b32 v157, v121
  ds_write_b32 v158, v122
  ds_write_b32 v159, v123
  s_mov_b64 exec, -1
  s_branch L3_noO
L3_w17:
  s_waitcnt vmcnt(7)
  ds_write_b32 v128, v92
  ds_write_b32 v129, v93
  ds_write_b32 v130, v94
  ds_write_b32 v131, v95
  s_waitcnt vmcnt(6)
  s_mov_b64 exec, 0xff
  ds_write_b32 v132, v96
  ds_write_b32 v133, v97
  ds_write_b32 v134, v98
  ds_write_b32 v135, v99
  s_mov_b64 exec, -1
  s_waitcnt vmcnt(5)
  ds_write_b32 v136, v100
  ds_write_b32 v137, v101
  ds_write_b32 v138, v102
  ds_write_b32 v139, v103
  s_waitcnt vmcnt(4)
  s_mov_b64 exec, 0xff
  ds_write_b32 v140, v104
  ds_write_b32 v141, v105
  ds_write_b32 v142, v106
  ds_write_b32 v143, v107
  s_mov_b64 exec, -1
  s_waitcnt vmcnt(3)
  ds_write_b32 v144, v108
  ds_write_b32 v145, v109
  ds_write_b32 v146, v110
  ds_write_b32 v147, v111
  s_waitcnt vmcnt(2)
  s_mov_b64 exec, 0xff
  ds_write_b32 v148, v112
  ds_write_b32 v149, v113
  ds_write_b32 v150, v114
  ds_write_b32 v151, v115
  s_mov_b64 exec, -1
  s_waitcnt vmcnt(1)
  ds_write_b32 v152, v116
  ds_write_b32 v153, v117
  ds_write_b32 v154, v118
  ds_write_b32 v155, v119
  s_waitcnt vmcnt(0)
  s_mov_b64 exec, 0xff
  ds_write_b32 v156, v120
  ds_write_b32 v157, v121
  ds_write_b32 v158, v122
  ds_write_b32 v159, v123
  s_mov_b64 exec, -1
L3_noO:
  s_waitcnt vmcnt(0) lgkmcnt(0)
  s_barrier
  v_lshrrev_b32 v7, 1, v3
  v_xor_b32 v7, v7, v4
  v_mul_u32_u24 v6, 1152, v3
  v_lshl_add_u32 v6, v7, 4, v6
  v_add_u32 v6, 49152, v6
  v_xor_b32 v162, 64, v6
  s_and_b32 s52, s42, 1
  s_mul_i32 s52, s52, 16*1152
  v_add_u32 v7, s52, v6
  v_add_u32 v163, s52, v162
  v_add_u32 v14, 112640, v5
  v_lshrrev_b32 v154, 2, v2
  v_and_b32 v154, 3, v154
  v_lshl_add_u32 v154, v4, 2, v154
  v_lshlrev_b32 v154, 6, v154
  v_and_b32 v155, 3, v2
  v_lshl_add_u32 v154, v155, 3, v154
  v_add_u32 v154, 90112, v154
  s_lshl_b32 s56, s42, 10
  v_add_u32 v155, s56, v154
  ds_read_b64_tr_b16 v[148:149], v155
  ds_read_b64_tr_b16 v[150:151], v155 offset:32
  s_and_b32 s59, s42, 1
  s_lshl_b32 s56, s59, 5
  s_add_u32 s56, s56, 8*1024
  v_add_u32 v155, s56, v154
  ds_read_b64_tr_b16 v[152:153], v155
  v_mul_u32_u24 v8, 304, v3
  v_lshl_add_u32 v8, v4, 3, v8
  v_add_u32 v15, 131072, v8
  s_lshl_b32 s56, s42, 5
  v_add_u32 v19, s56, v15
  ds_read_b64 v[8:9], v19
  ds_read_b64 v[10:11], v19 offset:4864
  s_mul_i32 s56, s59, 16*304
  s_add_u32 s56, s56, 256
  v_add_u32 v19, s56, v15
  ds_read_b64 v[12:13], v19
  s_cmp_eq_u32 s59, 0
  s_cselect_b64 vcc, -1, 0
  v_cndmask_b32 v18, v17, v16, vcc
  s_cmp_ge_u32 s42, 6
  s_cbranch_scc1 L3_k3
  ds_read_b128 v[104:107], v6 offset:0
  ds_read_b128 v[108:111], v6 offset:18432
  ds_read_b128 v[112:115], v162 offset:0
  ds_read_b128 v[116:119], v162 offset:18432
  ds_read_b128 v[120:123], v6 offset:128
  ds_read_b128 v[124:127], v6 offset:18560
  s_waitcnt lgkmcnt(4)
  v_mfma_f32_16x16x32_bf16 v[92:95], v[20:23], v[104:107], 0
  v_mfma_f32_16x16x32_bf16 v[96:99], v[20:23], v[108:111], 0
  v_sub_f32 v164, 1.0, v16
  v_lshlrev_b32 v136, 16, v8
  v_lshlrev_b32 v167, 16, v148
  v_mul_f32 v136, v136, v167
  ds_read_b128 v[104:107], v162 offset:128
  ds_read_b128 v[108:111], v162 offset:18560
  s_waitcnt lgkmcnt(4)
  v_mfma_f32_16x16x32_bf16 v[92:95], v[24:27], v[112:115], v[92:95]
  v_mfma_f32_16x16x32_bf16 v[96:99], v[24:27], v[116:119], v[96:99]
  v_mul_f32 v136, v136, v164
  v_and_b32 v137, 0xffff0000, v8
  v_and_b32 v167, 0xffff0000, v148
  v_mul_f32 v137, v137, v167
  ds_read_b128 v[112:115], v6 offset:256
  ds_read_b128 v[116:119], v6 offset:18688
  s_waitcnt lgkmcnt(4)
  v_mfma_f32_16x16x32_bf16 v[92:95], v[28:31], v[120:123], v[92:95]
  v_mfma_f32_16x16x32_bf16 v[96:99], v[28:31], v[124:127], v[96:99]
  v_mul_f32 v137, v137, v164
  v_lshlrev_b32 v138, 16, v9
  v_lshlrev_b32 v167, 16, v149
  v_mul_f32 v138, v138, v167
  ds_read_b128 v[120:123], v162 offset:256
  ds_read_b128 v[124:127], v162 offset:18688
  s_waitcnt lgkmcnt(4)
  v_mfma_f32_16x16x32_bf16 v[92:95], v[32:35], v[104:107], v[92:95]
  v_mfma_f32_16x16x32_bf16 v[96:99], v[32:35], v[108:111], v[96:99]
  v_mul_f32 v138, v138, v164
  v_and_b32 v139, 0xffff0000, v9
  v_and_b32 v167, 0xffff0000, v149
  v_mul_f32 v139, v139, v167
  ds_read_b128 v[104:107], v6 offset:384
  ds_read_b128 v[108:111], v6 offset:18816
  s_waitcnt lgkmcnt(4)
  v_mfma_f32_16x16x32_bf16 v[92:95], v[36:39], v[112:115], v[92:95]
  v_mfma_f32_16x16x32_bf16 v[96:99], v[36:39], v[116:119], v[96:99]
  v_mul_f32 v139, v139, v164
  v_sub_f32 v165, 1.0, v17
  v_lshlrev_b32 v140, 16, v10
  v_lshlrev_b32 v167, 16, v150
  ds_read_b128 v[112:115], v162 offset:384
  ds_read_b128 v[116:119], v162 offset:18816
  s_waitcnt lgkmcnt(4)
  v_mfma_f32_16x16x32_bf16 v[92:95], v[40:43], v[120:123], v[92:95]
  v_mfma_f32_16x16x32_bf16 v[96:99], v[40:43], v[124:127], v[96:99]
  v_mul_f32 v140, v140, v167
  v_mul_f32 v140, v140, v165
  v_and_b32 v141, 0xffff0000, v10
  v_and_b32 v167, 0xffff0000, v150
  ds_read_b128 v[120:123], v6 offset:512
  ds_read_b128 v[124:127], v6 offset:18944
  s_waitcnt lgkmcnt(4)
  v_mfma_f32_16x16x32_bf16 v[92:95], v[44:47], v[104:107], v[92:95]
  v_mfma_f32_16x16x32_bf16 v[96:99], v[44:47], v[108:111], v[96:99]
  v_mul_f32 v141, v141, v167
  v_mul_f32 v141, v141, v165
  v_lshlrev_b32 v142, 16, v11
  v_lshlrev_b32 v167, 16, v151
  ds_read_b128 v[104:107], v162 offset:512
  ds_read_b128 v[108:111], v162 offset:18944
  s_waitcnt lgkmcnt(4)
  v_mfma_f32_16x16x32_bf16 v[92:95], v[48:51], v[112:115], v[92:95]
  v_mfma_f32_16x16x32_bf16 v[96:99], v[48:51], v[116:119], v[96:99]
  v_mul_f32 v142, v142, v167
  v_mul_f32 v142, v142, v165
  v_and_b32 v143, 0xffff0000, v11
  v_and_b32 v167, 0xffff0000, v151
  ds_read_b128 v[112:115], v6 offset:640
  ds_read_b128 v[116:119], v6 offset:19072
  s_waitcnt lgkmcnt(4)
  v_mfma_f32_16x16x32_bf16 v[92:95], v[52:55], v[120:123], v[92:95]
  v_mfma_f32_16x16x32_bf16 v[96:99], v[52:55], v[124:127], v[96:99]
  v_mul_f32 v143, v143, v167
  v_mul_f32 v143, v143, v165
  v_sub_f32 v166, 1.0, v18
  v_lshlrev_b32 v144, 16, v12
  ds_read_b128 v[120:123], v162 offset:640
  ds_read_b128 v[124:127], v162 offset:19072
  s_waitcnt lgkmcnt(4)
  v_mfma_f32_16x16x32_bf16 v[92:95], v[56:59], v[104:107], v[92:95]
  v_mfma_f32_16x16x32_bf16 v[96:99], v[56:59], v[108:111], v[96:99]
  v_lshlrev_b32 v167, 16, v152
  v_mul_f32 v144, v144, v167
  v_mul_f32 v144, v144, v166
  v_and_b32 v145, 0xffff0000, v12
  ds_read_b128 v[104:107], v6 offset:768
  ds_read_b128 v[108:111], v6 offset:19200
  s_waitcnt lgkmcnt(4)
  v_mfma_f32_16x16x32_bf16 v[92:95], v[60:63], v[112:115], v[92:95]
  v_mfma_f32_16x16x32_bf16 v[96:99], v[60:63], v[116:119], v[96:99]
  v_and_b32 v167, 0xffff0000, v152
  v_mul_f32 v145, v145, v167
  v_mul_f32 v145, v145, v166
  v_lshlrev_b32 v146, 16, v13
  ds_read_b128 v[112:115], v162 offset:768
  ds_read_b128 v[116:119], v162 offset:19200
  s_waitcnt lgkmcnt(4)
  v_mfma_f32_16x16x32_bf16 v[92:95], v[64:67], v[120:123], v[92:95]
  v_mfma_f32_16x16x32_bf16 v[96:99], v[64:67], v[124:127], v[96:99]
  v_lshlrev_b32 v167, 16, v153
  v_mul_f32 v146, v146, v167
  v_mul_f32 v146, v146, v166
  v_and_b32 v147, 0xffff0000, v13
  ds_read_b128 v[120:123], v6 offset:896
  ds_read_b128 v[124:127], v6 offset:19328
  s_waitcnt lgkmcnt(4)
  v_mfma_f32_16x16x32_bf16 v[92:95], v[68:71], v[104:107], v[92:95]
  v_mfma_f32_16x16x32_bf16 v[96:99], v[68:71], v[108:111], v[96:99]
  v_and_b32 v167, 0xffff0000, v153
  v_mul_f32 v147, v147, v167
  v_mul_f32 v147, v147, v166
  ds_read_b128 v[104:107], v162 offset:896
  ds_read_b128 v[108:111], v162 offset:19328
  s_waitcnt lgkmcnt(4)
  v_mfma_f32_16x16x32_bf16 v[92:95], v[72:75], v[112:115], v[92:95]
  v_mfma_f32_16x16x32_bf16 v[96:99], v[72:75], v[116:119], v[96:99]
  ds_read_b128 v[112:115], v6 offset:1024
  ds_read_b128 v[116:119], v6 offset:19456
  s_waitcnt lgkmcnt(4)
  v_mfma_f32_16x16x32_bf16 v[92:95], v[76:79], v[120:123], v[92:95]
  v_mfma_f32_16x16x32_bf16 v[96:99], v[76:79], v[124:127], v[96:99]
  ds_read_b128 v[120:123], v162 offset:1024
  ds_read_b128 v[124:127], v162 offset:19456
  s_waitcnt lgkmcnt(4)
  v_mfma_f32_16x16x32_bf16 v[92:95], v[80:83], v[104:107], v[92:95]
  v_mfma_f32_16x16x32_bf16 v[96:99], v[80:83], v[108:111], v[96:99]
  s_waitcnt lgkmcnt(2)
  v_mfma_f32_16x16x32_bf16 v[92:95], v[84:87], v[112:115], v[92:95]
  v_mfma_f32_16x16x32_bf16 v[96:99], v[84:87], v[116:119], v[96:99]
  s_waitcnt lgkmcnt(0)
  v_mfma_f32_16x16x32_bf16 v[92:95], v[88:91], v[120:123], v[92:95]
  v_mfma_f32_16x16x32_bf16 v[96:99], v[88:91], v[124:127], v[96:99]
  s_branch L3_kdone
L3_k3:
  ds_read_b128 v[104:107], v6 offset:0
  ds_read_b128 v[108:111], v6 offset:18432
  ds_read_b128 v[112:115], v7 offset:0
  ds_read_b128 v[128:131], v14 offset:0
  ds_read_b128 v[116:119], v162 offset:0
  ds_read_b128 v[120:123], v162 offset:18432
  ds_read_b128 v[124:127], v163 offset:0
  ds_read_b128 v[132:135], v14 offset:1024
  s_waitcnt lgkmcnt(4)
  v_mfma_f32_16x16x32_bf16 v[92:95], v[20:23], v[104:107], 0
  v_mfma_f32_16x16x32_bf16 v[96:99], v[20:23], v[108:111], 0
  v_mfma_f32_16x16x32_bf16 v[100:103], v[128:131], v[112:115], 0
  v_sub_f32 v164, 1.0, v16
  v_lshlrev_b32 v136, 16, v8
  v_lshlrev_b32 v167, 16, v148
  v_mul_f32 v136, v136, v167
  ds_read_b128 v[104:107], v6 offset:128
  ds_read_b128 v[108:111], v6 offset:18560
  ds_read_b128 v[112:115], v7 offset:128
  ds_read_b128 v[128:131], v14 offset:2048
  s_waitcnt lgkmcnt(4)
  v_mfma_f32_16x16x32_bf16 v[92:95], v[24:27], v[116:119], v[92:95]
  v_mfma_f32_16x16x32_bf16 v[96:99], v[24:27], v[120:123], v[96:99]
  v_mfma_f32_16x16x32_bf16 v[100:103], v[132:135], v[124:127], v[100:103]
  v_mul_f32 v136, v136, v164
  v_and_b32 v137, 0xffff0000, v8
  v_and_b32 v167, 0xffff0000, v148
  v_mul_f32 v137, v137, v167
  ds_read_b128 v[116:119], v162 offset:128
  ds_read_b128 v[120:123], v162 offset:18560
  ds_read_b128 v[124:127], v163 offset:128
  ds_read_b128 v[132:135], v14 offset:3072
  s_waitcnt lgkmcnt(4)
  v_mfma_f32_16x16x32_bf16 v[92:95], v[28:31], v[104:107], v[92:95]
  v_mfma_f32_16x16x32_bf16 v[96:99], v[28:31], v[108:111], v[96:99]
  v_mfma_f32_16x16x32_bf16 v[100:103], v[128:131], v[112:115], v[100:103]
  v_mul_f32 v137, v137, v164
  v_lshlrev_b32 v138, 16, v9
  v_lshlrev_b32 v167, 16, v149
  v_mul_f32 v138, v138, v167
  ds_read_b128 v[104:107], v6 offset:256
  ds_read_b128 v[108:111], v6 offset:18688
  ds_read_b128 v[112:115], v7 offset:256
  ds_read_b128 v[128:131], v14 offset:4096
  s_waitcnt lgkmcnt(4)
  v_mfma_f32_16x16x32_bf16 v[92:95], v[32:35], v[116:119], v[92:95]
  v_mfma_f32_16x16x32_bf16 v[96:99], v[32:35], v[120:123], v[96:99]
  v_mfma_f32_16x16x32_bf16 v[100:103], v[132:135], v[124:127], v[100:103]
  v_mul_f32 v138, v138, v164
  v_and_b32 v139, 0xffff0000, v9
  v_and_b32 v167, 0xffff0000, v149
  v_mul_f32 v139, v139, v167
  ds_read_b128 v[116:119], v162 offset:256
  ds_read_b128 v[120:123], v162 offset:18688
  ds_read_b128 v[124:127], v163 offset:256
  ds_read_b128 v[132:135], v14 offset:5120
  s_waitcnt lgkmcnt(4)
  v_mfma_f32_16x16x32_bf16 v[92:95], v[36:39], v[104:107], v[92:95]
  v_mfma_f32_16x16x32_bf16 v[96:99], v[36:39], v[108:111], v[96:99]
  v_mfma_f32_16x16x32_bf16 v[100:103], v[128:131], v[112:115], v[100:103]
  v_mul_f32 v139, v139, v164
  v_sub_f32 v165, 1.0, v17
  v_lshlrev_b32 v140, 16, v10
  v_lshlrev_b32 v167, 16, v150
  ds_read_b128 v[104:107], v6 offset:384
  ds_read_b128 v[108:111], v6 offset:18816
  ds_read_b128 v[112:115], v7 offset:384
  ds_read_b128 v[128:131], v14 offset:6144
  s_waitcnt lgkmcnt(4)
  v_mfma_f32_16x16x32_bf16 v[92:95], v[40:43], v[116:119], v[92:95]
  v_mfma_f32_16x16x32_bf16 v[96:99], v[40:43], v[120:123], v[96:99]
  v_mfma_f32_16x16x32_bf16 v[100:103], v[132:135], v[124:127], v[100:103]
  v_mul_f32 v140, v140, v167
  v_mul_f32 v140, v140, v165
  v_and_b32 v141, 0xffff0000, v10
  v_and_b32 v167, 0xffff0000, v150
  ds_read_b128 v[116:119], v162 offset:384
  ds_read_b128 v[120:123], v162 offset:18816
  ds_read_b128 v[124:127], v163 offset:384
  ds_read_b128 v[132:135], v14 offset:7168
  s_waitcnt lgkmcnt(4)
  v_mfma_f32_16x16x32_bf16 v[92:95], v[44:47], v[104:107], v[92:95]
  v_mfma_f32_16x16x32_bf16 v[96:99], v[44:47], v[108:111], v[96:99]
  v_mfma_f32_16x16x32_bf16 v[100:103], v[128:131], v[112:115], v[100:103]
  v_mul_f32 v141, v141, v167
  v_mul_f32 v141, v141, v165
  v_lshlrev_b32 v142, 16, v11
  v_lshlrev_b32 v167, 16, v151
  ds_read_b128 v[104:107], v6 offset:512
  ds_read_b128 v[108:111], v6 offset:18944
  ds_read_b128 v[112:115], v7 offset:512
  ds_read_b128 v[128:131], v14 offset:8192
  s_waitcnt lgkmcnt(4)
  v_mfma_f32_16x16x32_bf16 v[92:95], v[48:51], v[116:119], v[92:95]
  v_mfma_f32_16x16x32_bf16 v[96:99], v[48:51], v[120:123], v[96:99]
  v_mfma_f32_16x16x32_bf16 v[100:103], v[132:135], v[124:127], v[100:103]
  v_mul_f32 v142, v142, v167
  v_mul_f32 v142, v142, v165
  v_and_b32 v143, 0xffff0000, v11
  v_and_b32 v167, 0xffff0000, v151
  ds_read_b128 v[116:119], v162 offset:512
  ds_read_b128 v[120:123], v162 offset:18944
  ds_read_b128 v[124:127], v163 offset:512
  ds_read_b128 v[132:135], v14 offset:9216
  s_waitcnt lgkmcnt(4)
  v_mfma_f32_16x16x32_bf16 v[92:95], v[52:55], v[104:107], v[92:95]
  v_mfma_f32_16x16x32_bf16 v[96:99], v[52:55], v[108:111], v[96:99]
  v_mfma_f32_16x16x32_bf16 v[100:103], v[128:131], v[112:115], v[100:103]
  v_mul_f32 v143, v143, v167
  v_mul_f32 v143, v143, v165
  v_sub_f32 v166, 1.0, v18
  v_lshlrev_b32 v144, 16, v12
  ds_read_b128 v[104:107], v6 offset:640
  ds_read_b128 v[108:111], v6 offset:19072
  ds_read_b128 v[112:115], v7 offset:640
  ds_read_b128 v[128:131], v14 offset:10240
  s_waitcnt lgkmcnt(4)
  v_mfma_f32_16x16x32_bf16 v[92:95], v[56:59], v[116:119], v[92:95]
  v_mfma_f32_16x16x32_bf16 v[96:99], v[56:59], v[120:123], v[96:99]
  v_mfma_f32_16x16x32_bf16 v[100:103], v[132:135], v[124:127], v[100:103]
  v_lshlrev_b32 v167, 16, v152
  v_mul_f32 v144, v144, v167
  v_mul_f32 v144, v144, v166
  v_and_b32 v145, 0xffff0000, v12
  ds_read_b128 v[116:119], v162 offset:640
  ds_read_b128 v[120:123], v162 offset:19072
  ds_read_b128 v[124:127], v163 offset:640
  ds_read_b128 v[132:135], v14 offset:11264
  s_waitcnt lgkmcnt(4)
  v_mfma_f32_16x16x32_bf16 v[92:95], v[60:63], v[104:107], v[92:95]
  v_mfma_f32_16x16x32_bf16 v[96:99], v[60:63], v[108:111], v[96:99]
  v_mfma_f32_16x16x32_bf16 v[100:103], v[128:131], v[112:115], v[100:103]
  v_and_b32 v167, 0xffff0000, v152
  v_mul_f32 v145, v145, v167
  v_mul_f32 v145, v145, v166
  v_lshlrev_b32 v146, 16, v13
  ds_read_b128 v[104:107], v6 offset:768
  ds_read_b128 v[108:111], v6 offset:19200
  ds_read_b128 v[112:115], v7 offset:768
  ds_read_b128 v[128:131], v14 offset:12288
  s_waitcnt lgkmcnt(4)
  v_mfma_f32_16x16x32_bf16 v[92:95], v[64:67], v[116:119], v[92:95]
  v_mfma_f32_16x16x32_bf16 v[96:99], v[64:67], v[120:123], v[96:99]
  v_mfma_f32_16x16x32_bf16 v[100:103], v[132:135], v[124:127], v[100:103]
  v_lshlrev_b32 v167, 16, v153
  v_mul_f32 v146, v146, v167
  v_mul_f32 v146, v146, v166
  v_and_b32 v147, 0xffff0000, v13
  ds_read_b128 v[116:119], v162 offset:768
  ds_read_b128 v[120:123], v162 offset:19200
  ds_read_b128 v[124:127], v163 offset:768
  ds_read_b128 v[132:135], v14 offset:13312
  s_waitcnt lgkmcnt(4)
  v_mfma_f32_16x16x32_bf16 v[92:95], v[68:71], v[104:107], v[92:95]
  v_mfma_f32_16x16x32_bf16 v[96:99], v[68:71], v[108:111], v[96:99]
  v_mfma_f32_16x16x32_bf16 v[100:103], v[128:131], v[112:115], v[100:103]
  v_and_b32 v167, 0xffff0000, v153
  v_mul_f32 v147, v147, v167
  v_mul_f32 v147, v147, v166
  ds_read_b128 v[104:107], v6 offset:896
  ds_read_b128 v[108:111], v6 offset:19328
  ds_read_b128 v[112:115], v7 offset:896
  ds_read_b128 v[128:131], v14 offset:14336
  s_waitcnt lgkmcnt(4)
  v_mfma_f32_16x16x32_bf16 v[92:95], v[72:75], v[116:119], v[92:95]
  v_mfma_f32_16x16x32_bf16 v[96:99], v[72:75], v[120:123], v[96:99]
  v_mfma_f32_16x16x32_bf16 v[100:103], v[132:135], v[124:127], v[100:103]
  ds_read_b128 v[116:119], v162 offset:896
  ds_read_b128 v[120:123], v162 offset:19328
  ds_read_b128 v[124:127], v163 offset:896
  ds_read_b128 v[132:135], v14 offset:15360
  s_waitcnt lgkmcnt(4)
  v_mfma_f32_16x16x32_bf16 v[92:95], v[76:79], v[104:107], v[92:95]
  v_mfma_f32_16x16x32_bf16 v[96:99], v[76:79], v[108:111], v[96:99]
  v_mfma_f32_16x16x32_bf16 v[100:103], v[128:131], v[112:115], v[100:103]
  ds_read_b128 v[104:107], v6 offset:1024
  ds_read_b128 v[108:111], v6 offset:19456
  ds_read_b128 v[112:115], v7 offset:1024
  ds_read_b128 v[128:131], v14 offset:16384
  s_waitcnt lgkmcnt(4)
  v_mfma_f32_16x16x32_bf16 v[92:95], v[80:83], v[116:119], v[92:95]
  v_mfma_f32_16x16x32_bf16 v[96:99], v[80:83], v[120:123], v[96:99]
  v_mfma_f32_16x16x32_bf16 v[100:103], v[132:135], v[124:127], v[100:103]
  ds_read_b128 v[116:119], v162 offset:1024
  ds_read_b128 v[120:123], v162 offset:19456
  ds_read_b128 v[124:127], v163 offset:1024
  ds_read_b128 v[132:135], v14 offset:17408
  s_waitcnt lgkmcnt(4)
  v_mfma_f32_16x16x32_bf16 v[92:95], v[84:87], v[104:107], v[92:95]
  v_mfma_f32_16x16x32_bf16 v[96:99], v[84:87], v[108:111], v[96:99]
  v_mfma_f32_16x16x32_bf16 v[100:103], v[128:131], v[112:115], v[100:103]
  s_waitcnt lgkmcnt(0)
  v_mfma_f32_16x16x32_bf16 v[92:95], v[88:91], v[116:119], v[92:95]
  v_mfma_f32_16x16x32_bf16 v[96:99], v[88:91], v[120:123], v[96:99]
  v_mfma_f32_16x16x32_bf16 v[100:103], v[132:135], v[124:127], v[100:103]
L3_kdone:
  v_mul_u32_u24 v154, 304, v3
  v_lshl_add_u32 v154, v4, 3, v154
  v_add_u32 v154, 102400, v154
  s_lshl_b32 s56, s42, 5
  v_add_u32 v155, s56, v154
  s_nop 2
  v_fma_f32 v92, v92, v16, v136
  v_fma_f32 v93, v93, v16, v137
  v_fma_f32 v94, v94, v16, v138
  v_fma_f32 v95, v95, v16, v139
  v_cvt_pk_bf16_f32 v104, v92, v93
  v_cvt_pk_bf16_f32 v105, v94, v95
  v_fma_f32 v96, v96, v17, v140
  v_fma_f32 v97, v97, v17, v141
  v_fma_f32 v98, v98, v17, v142
  v_fma_f32 v99, v99, v17, v143
  v_cvt_pk_bf16_f32 v106, v96, v97
  v_cvt_pk_bf16_f32 v107, v98, v99
  ds_write_b64 v155, v[104:105]
  ds_write_b64 v155, v[106:107] offset:4864
  s_cmp_lt_u32 s42, 6
  s_cbranch_scc1 L3_edone
  v_fma_f32 v100, v100, v18, v144
  v_fma_f32 v101, v101, v18, v145
  v_fma_f32 v102, v102, v18, v146
  v_fma_f32 v103, v103, v18, v147
  v_cvt_pk_bf16_f32 v108, v100, v101
  v_cvt_pk_bf16_f32 v109, v102, v103
  s_mul_i32 s56, s59, 16*304
  s_add_u32 s56, s56, 256
  v_add_u32 v155, s56, v154
  ds_write_b64 v155, v[108:109]
L3_edone:
  s_waitcnt lgkmcnt(0)
  s_barrier
  s_movk_i32 s56, 3641
  s_lshl_b32 s57, s42, 6
  v_add_u32 v6, s57, v2
  v_mul_u32_u24 v7, s56, v6
  v_lshrrev_b32 v7, 16, v7
  v_mul_u32_u24 v8, 18, v7
  v_sub_u32 v8, v6, v8
  v_mul_u32_u24 v9, 304, v7
  v_lshl_add_u32 v9, v8, 4, v9
  v_add_u32 v9, 102400, v9
  ds_read_b128 v[24:27], v9
  v_add_u32 v7, s43, v7
  v_mul_u32_u24 v7, 1152, v7
  v_lshl_add_u32 v7, v8, 4, v7
  s_waitcnt lgkmcnt(0)
  buffer_store_dwordx4 v[24:27], v7, s[20:23], s47 offen nt
  s_cmp_lg_u32 s42, 0
  s_cbranch_scc1 L_fin
  s_lshl_b32 s57, s42, 6
  v_add_u32 v6, s57, v2
  v_add_u32 v6, 512, v6
  v_mul_u32_u24 v7, s56, v6
  v_lshrrev_b32 v7, 16, v7
  v_mul_u32_u24 v8, 18, v7
  v_sub_u32 v8, v6, v8
  v_mul_u32_u24 v9, 304, v7
  v_lshl_add_u32 v9, v8, 4, v9
  v_add_u32 v9, 102400, v9
  ds_read_b128 v[24:27], v9
  v_add_u32 v7, s43, v7
  v_mul_u32_u24 v7, 1152, v7
  v_lshl_add_u32 v7, v8, 4, v7
  s_waitcnt lgkmcnt(0)
  buffer_store_dwordx4 v[24:27], v7, s[20:23], s47 offen nt
  s_branch L_fin
L2_conv:
  s_sub_u32 s43, s42, 8
  s_lshl_b32 s44, s43, 8
  s_add_u32 s44, s44, s2
  s_cmp_eq_u32 s43, 2
  s_cbranch_scc0 Lch_23
  s_add_u32 s44, s2, 320
  s_cmp_lt_u32 s2, 192
  s_cselect_b32 s44, 0xffff, s44
Lch_23:
  s_cmp_ge_u32 s44, 576
  s_cbranch_scc1 L_fin
  s_load_dwordx2 s[10:11], s[0:1], 64
  s_mul_hi_u32 s45, s44, 0x5555556
  s_add_u32 s45, s45, 128
  s_lshl_b32 s45, s45, 7
  s_add_u32 s45, s45, 0x14c4000
  v_mov_b32 v5, s45
  v_mov_b32 v6, 16
  s_mov_b32 s57, 200000
Lpoll_24:
  buffer_load_dword v7, v5, s[36:39], 0 offen sc1
  s_waitcnt vmcnt(0)
  v_cmp_lt_u32 vcc, v7, v6
  s_nop 3
  s_cmp_eq_u64 vcc, 0
  s_cbranch_scc1 Lpoll_24_x
  s_sleep 6
  s_sub_u32 s57, s57, 1
  s_cmp_lg_u32 s57, 0
  s_cbranch_scc1 Lpoll_24
Lpoll_24_x:
  v_lshlrev_b32 v3, 4, v2
  s_lshl_b32 s46, s44, 12
  s_add_u32 s46, s46, 0x6c0000
  s_mul_i32 s47, s43, 4608
  s_add_u32 s47, s47, 147456
  buffer_load_dwordx4 v[8:11], v3, s[36:39], s46 offen offset:0 sc1
  buffer_load_dwordx4 v[12:15], v3, s[36:39], s46 offen offset:1024 sc1
  buffer_load_dwordx4 v[16:19], v3, s[36:39], s46 offen offset:2048 sc1
  buffer_load_dwordx4 v[20:23], v3, s[36:39], s46 offen offset:3072 sc1
  s_mul_i32 s48, s44, 10240
  s_add_u32 s48, s48, 0x900000
  v_and_b32 v4, 15, v2
  v_lshrrev_b32 v5, 4, v2
  v_and_b32 v6, 7, v4
  v_lshlrev_b32 v6, 1, v6
  v_lshrrev_b32 v7, 3, v4
  v_lshl_add_u32 v6, v7, 1, v6
  v_lshl_add_u32 v6, v5, 3, v6
  v_lshlrev_b32 v6, 1, v6
  v_mov_b32 v24, 5120
  v_cmp_eq_u32 vcc, 0, v7
  v_mov_b32 v25, 0
  s_nop 0
  v_cndmask_b32 v24, v25, v24, vcc
  v_add_u32 v6, v6, v24
  v_lshlrev_b32 v7, 5, v4
  v_lshlrev_b32 v24, 4, v5
  v_sub_u32 v7, v24, v7
  v_add_u32 v7, s47, v7
  v_add_u32 v7, 4064, v7
  buffer_load_dwordx4 v[112:115], v6, s[36:39], s48 offen offset:0
  buffer_load_dwordx4 v[116:119], v6, s[36:39], s48 offen offset:512
  buffer_load_dwordx4 v[120:123], v6, s[36:39], s48 offen offset:1024
  buffer_load_dwordx4 v[124:127], v6, s[36:39], s48 offen offset:1536
  buffer_load_dwordx4 v[128:131], v6, s[36:39], s48 offen offset:2048
  buffer_load_dwordx4 v[132:135], v6, s[36:39], s48 offen offset:2560
  buffer_load_dwordx4 v[136:139], v6, s[36:39], s48 offen offset:3072
  buffer_load_dwordx4 v[140:143], v6, s[36:39], s48 offen offset:3584
  v_add_u32 v26, s47, v3
  s_waitcnt vmcnt(11)
  ds_write_b128 v26, v[8:11] offset:0
  s_waitcnt vmcnt(10)
  ds_write_b128 v26, v[12:15] offset:1024
  s_waitcnt vmcnt(9)
  ds_write_b128 v26, v[16:19] offset:2048
  s_waitcnt vmcnt(8)
  ds_write_b128 v26, v[20:23] offset:3072
  v_mov_b32 v28, 0
  v_mov_b32 v29, 0
  v_mov_b32 v30, 0
  v_mov_b32 v31, 0
  s_mov_b32 exec_hi, 0
  ds_write_b128 v26, v[28:31] offset:4096
  s_mov_b64 exec, -1
  v_mov_b32 v80, 0
  v_mov_b32 v81, 0
  v_mov_b32 v82, 0
  v_mov_b32 v83, 0
  v_mov_b32 v84, 0
  v_mov_b32 v85, 0
  v_mov_b32 v86, 0
  v_mov_b32 v87, 0
  v_mov_b32 v88, 0
  v_mov_b32 v89, 0
  v_mov_b32 v90, 0
  v_mov_b32 v91, 0
  v_mov_b32 v92, 0
  v_mov_b32 v93, 0
  v_mov_b32 v94, 0
  v_mov_b32 v95, 0
  v_mov_b32 v96, 0
  v_mov_b32 v97, 0
  v_mov_b32 v98, 0
  v_mov_b32 v99, 0
  v_mov_b32 v100, 0
  v_mov_b32 v101, 0
  v_mov_b32 v102, 0
  v_mov_b32 v103, 0
  v_mov_b32 v104, 0
  v_mov_b32 v105, 0
  v_mov_b32 v106, 0
  v_mov_b32 v107, 0
  v_mov_b32 v108, 0
  v_mov_b32 v109, 0
  v_mov_b32 v110, 0
  v_mov_b32 v111, 0
  s_waitcnt lgkmcnt(0)
  s_setprio 1
  s_mov_b32 s51, 0
L2c_rho:
  s_add_u32 s52, s51, 0
  s_lshl_b32 s52, s52, 6
  v_add_u32 v8, s52, v7
  v_subrev_u32 v8, 3584, v8
  ds_read_b128 v[48:51], v8 offset:3584
  ds_read_b128 v[52:55], v8 offset:3072
  ds_read_b128 v[56:59], v8 offset:2560
  ds_read_b128 v[60:63], v8 offset:2048
  ds_read_b128 v[64:67], v8 offset:1536
  ds_read_b128 v[68:71], v8 offset:1024
  ds_read_b128 v[72:75], v8 offset:512
  ds_read_b128 v[76:79], v8 offset:0
  s_add_u32 s53, s52, 64
  s_and_b32 s53, s53, 0x1ff
  s_add_u32 s53, s53, s48
  buffer_load_dwordx4 v[16:19], v6, s[36:39], s53 offen offset:0
  buffer_load_dwordx4 v[20:23], v6, s[36:39], s53 offen offset:512
  buffer_load_dwordx4 v[24:27], v6, s[36:39], s53 offen offset:1024
  buffer_load_dwordx4 v[28:31], v6, s[36:39], s53 offen offset:1536
  buffer_load_dwordx4 v[32:35], v6, s[36:39], s53 offen offset:2048
  buffer_load_dwordx4 v[36:39], v6, s[36:39], s53 offen offset:2560
  buffer_load_dwordx4 v[40:43], v6, s[36:39], s53 offen offset:3072
  buffer_load_dwordx4 v[44:47], v6, s[36:39], s53 offen offset:3584
  s_waitcnt lgkmcnt(0)
  s_waitcnt vmcnt(15)
  v_mfma_f32_16x16x32_bf16 v[80:83], v[112:115], v[48:51], v[80:83]
  v_mfma_f32_16x16x32_bf16 v[84:87], v[112:115], v[52:55], v[84:87]
  v_mfma_f32_16x16x32_bf16 v[88:91], v[112:115], v[56:59], v[88:91]
  v_mfma_f32_16x16x32_bf16 v[92:95], v[112:115], v[60:63], v[92:95]
  v_mfma_f32_16x16x32_bf16 v[96:99], v[112:115], v[64:67], v[96:99]
  v_mfma_f32_16x16x32_bf16 v[100:103], v[112:115], v[68:71], v[100:103]
  v_mfma_f32_16x16x32_bf16 v[104:107], v[112:115], v[72:75], v[104:107]
  v_mfma_f32_16x16x32_bf16 v[108:111], v[112:115], v[76:79], v[108:111]
  s_waitcnt vmcnt(14)
  v_mfma_f32_16x16x32_bf16 v[84:87], v[116:119], v[48:51], v[84:87]
  v_mfma_f32_16x16x32_bf16 v[88:91], v[116:119], v[52:55], v[88:91]
  v_mfma_f32_16x16x32_bf16 v[92:95], v[116:119], v[56:59], v[92:95]
  v_mfma_f32_16x16x32_bf16 v[96:99], v[116:119], v[60:63], v[96:99]
  v_mfma_f32_16x16x32_bf16 v[100:103], v[116:119], v[64:67], v[100:103]
  v_mfma_f32_16x16x32_bf16 v[104:107], v[116:119], v[68:71], v[104:107]
  v_mfma_f32_16x16x32_bf16 v[108:111], v[116:119], v[72:75], v[108:111]
  s_waitcnt vmcnt(13)
  v_mfma_f32_16x16x32_bf16 v[88:91], v[120:123], v[48:51], v[88:91]
  v_mfma_f32_16x16x32_bf16 v[92:95], v[120:123], v[52:55], v[92:95]
  v_mfma_f32_16x16x32_bf16 v[96:99], v[120:123], v[56:59], v[96:99]
  v_mfma_f32_16x16x32_bf16 v[100:103], v[120:123], v[60:63], v[100:103]
  v_mfma_f32_16x16x32_bf16 v[104:107], v[120:123], v[64:67], v[104:107]
  v_mfma_f32_16x16x32_bf16 v[108:111], v[120:123], v[68:71], v[108:111]
  s_waitcnt vmcnt(12)
  v_mfma_f32_16x16x32_bf16 v[92:95], v[124:127], v[48:51], v[92:95]
  v_mfma_f32_16x16x32_bf16 v[96:99], v[124:127], v[52:55], v[96:99]
  v_mfma_f32_16x16x32_bf16 v[100:103], v[124:127], v[56:59], v[100:103]
  v_mfma_f32_16x16x32_bf16 v[104:107], v[124:127], v[60:63], v[104:107]
  v_mfma_f32_16x16x32_bf16 v[108:111], v[124:127], v[64:67], v[108:111]
  s_waitcnt vmcnt(11)
  v_mfma_f32_16x16x32_bf16 v[96:99], v[128:131], v[48:51], v[96:99]
  v_mfma_f32_16x16x32_bf16 v[100:103], v[128:131], v[52:55], v[100:103]
  v_mfma_f32_16x16x32_bf16 v[104:107], v[128:131], v[56:59], v[104:107]
  v_mfma_f32_16x16x32_bf16 v[108:111], v[128:131], v[60:63], v[108:111]
  s_waitcnt vmcnt(10)
  v_mfma_f32_16x16x32_bf16 v[100:103], v[132:135], v[48:51], v[100:103]
  v_mfma_f32_16x16x32_bf16 v[104:107], v[132:135], v[52:55], v[104:107]
  v_mfma_f32_16x16x32_bf16 v[108:111], v[132:135], v[56:59], v[108:111]
  s_waitcnt vmcnt(9)
  v_mfma_f32_16x16x32_bf16 v[104:107], v[136:139], v[48:51], v[104:107]
  v_mfma_f32_16x16x32_bf16 v[108:111], v[136:139], v[52:55], v[108:111]
  s_waitcnt vmcnt(8)
  v_mfma_f32_16x16x32_bf16 v[108:111], v[140:143], v[48:51], v[108:111]
  s_add_u32 s52, s51, 1
  s_lshl_b32 s52, s52, 6
  v_add_u32 v8, s52, v7
  v_subrev_u32 v8, 3584, v8
  ds_read_b128 v[48:51], v8 offset:3584
  ds_read_b128 v[52:55], v8 offset:3072
  ds_read_b128 v[56:59], v8 offset:2560
  ds_read_b128 v[60:63], v8 offset:2048
  ds_read_b128 v[64:67], v8 offset:1536
  ds_read_b128 v[68:71], v8 offset:1024
  ds_read_b128 v[72:75], v8 offset:512
  ds_read_b128 v[76:79], v8 offset:0
  s_add_u32 s53, s52, 64
  s_and_b32 s53, s53, 0x1ff
  s_add_u32 s53, s53, s48
  buffer_load_dwordx4 v[112:115], v6, s[36:39], s53 offen offset:0
  buffer_load_dwordx4 v[116:119], v6, s[36:39], s53 offen offset:512
  buffer_load_dwordx4 v[120:123], v6, s[36:39], s53 offen offset:1024
  buffer_load_dwordx4 v[124:127], v6, s[36:39], s53 offen offset:1536
  buffer_load_dwordx4 v[128:131], v6, s[36:39], s53 offen offset:2048
  buffer_load_dwordx4 v[132:135], v6, s[36:39], s53 offen offset:2560
  buffer_load_dwordx4 v[136:139], v6, s[36:39], s53 offen offset:3072
  buffer_load_dwordx4 v[140:143], v6, s[36:39], s53 offen offset:3584
  s_waitcnt lgkmcnt(0)
  s_waitcnt vmcnt(15)
  v_mfma_f32_16x16x32_bf16 v[80:83], v[16:19], v[48:51], v[80:83]
  v_mfma_f32_16x16x32_bf16 v[84:87], v[16:19], v[52:55], v[84:87]
  v_mfma_f32_16x16x32_bf16 v[88:91], v[16:19], v[56:59], v[88:91]
  v_mfma_f32_16x16x32_bf16 v[92:95], v[16:19], v[60:63], v[92:95]
  v_mfma_f32_16x16x32_bf16 v[96:99], v[16:19], v[64:67], v[96:99]
  v_mfma_f32_16x16x32_bf16 v[100:103], v[16:19], v[68:71], v[100:103]
  v_mfma_f32_16x16x32_bf16 v[104:107], v[16:19], v[72:75], v[104:107]
  v_mfma_f32_16x16x32_bf16 v[108:111], v[16:19], v[76:79], v[108:111]
  s_waitcnt vmcnt(14)
  v_mfma_f32_16x16x32_bf16 v[84:87], v[20:23], v[48:51], v[84:87]
  v_mfma_f32_16x16x32_bf16 v[88:91], v[20:23], v[52:55], v[88:91]
  v_mfma_f32_16x16x32_bf16 v[92:95], v[20:23], v[56:59], v[92:95]
  v_mfma_f32_16x16x32_bf16 v[96:99], v[20:23], v[60:63], v[96:99]
  v_mfma_f32_16x16x32_bf16 v[100:103], v[20:23], v[64:67], v[100:103]
  v_mfma_f32_16x16x32_bf16 v[104:107], v[20:23], v[68:71], v[104:107]
  v_mfma_f32_16x16x32_bf16 v[108:111], v[20:23], v[72:75], v[108:111]
  s_waitcnt vmcnt(13)
  v_mfma_f32_16x16x32_bf16 v[88:91], v[24:27], v[48:51], v[88:91]
  v_mfma_f32_16x16x32_bf16 v[92:95], v[24:27], v[52:55], v[92:95]
  v_mfma_f32_16x16x32_bf16 v[96:99], v[24:27], v[56:59], v[96:99]
  v_mfma_f32_16x16x32_bf16 v[100:103], v[24:27], v[60:63], v[100:103]
  v_mfma_f32_16x16x32_bf16 v[104:107], v[24:27], v[64:67], v[104:107]
  v_mfma_f32_16x16x32_bf16 v[108:111], v[24:27], v[68:71], v[108:111]
  s_waitcnt vmcnt(12)
  v_mfma_f32_16x16x32_bf16 v[92:95], v[28:31], v[48:51], v[92:95]
  v_mfma_f32_16x16x32_bf16 v[96:99], v[28:31], v[52:55], v[96:99]
  v_mfma_f32_16x16x32_bf16 v[100:103], v[28:31], v[56:59], v[100:103]
  v_mfma_f32_16x16x32_bf16 v[104:107], v[28:31], v[60:63], v[104:107]
  v_mfma_f32_16x16x32_bf16 v[108:111], v[28:31], v[64:67], v[108:111]
  s_waitcnt vmcnt(11)
  v_mfma_f32_16x16x32_bf16 v[96:99], v[32:35], v[48:51], v[96:99]
  v_mfma_f32_16x16x32_bf16 v[100:103], v[32:35], v[52:55], v[100:103]
  v_mfma_f32_16x16x32_bf16 v[104:107], v[32:35], v[56:59], v[104:107]
  v_mfma_f32_16x16x32_bf16 v[108:111], v[32:35], v[60:63], v[108:111]
  s_waitcnt vmcnt(10)
  v_mfma_f32_16x16x32_bf16 v[100:103], v[36:39], v[48:51], v[100:103]
  v_mfma_f32_16x16x32_bf16 v[104:107], v[36:39], v[52:55], v[104:107]
  v_mfma_f32_16x16x32_bf16 v[108:111], v[36:39], v[56:59], v[108:111]
  s_waitcnt vmcnt(9)
  v_mfma_f32_16x16x32_bf16 v[104:107], v[40:43], v[48:51], v[104:107]
  v_mfma_f32_16x16x32_bf16 v[108:111], v[40:43], v[52:55], v[108:111]
  s_waitcnt vmcnt(8)
  v_mfma_f32_16x16x32_bf16 v[108:111], v[44:47], v[48:51], v[108:111]
  s_add_u32 s51, s51, 2
  s_cmp_lt_u32 s51, 8
  s_cbranch_scc1 L2c_rho
L2c_skip:
  s_setprio 3
  s_waitcnt vmcnt(0)
  s_lshl_b32 s52, s44, 1
  s_and_b32 s53, s52, 0xfffffffc
  s_add_u32 s54, s10, s53
  s_addc_u32 s55, s11, 0
  s_load_dword s56, s[54:55], 0
  s_waitcnt lgkmcnt(0)
  s_and_b32 s57, s52, 2
  s_lshl_b32 s57, s57, 3
  s_lshr_b32 s56, s56, s57
  s_lshl_b32 s56, s56, 16
  v_and_b32 v8, 1, v5
  v_lshrrev_b32 v9, 1, v5
  v_lshlrev_b32 v10, 4, v4
  v_lshl_add_u32 v10, v8, 3, v10
  v_lshl_add_u32 v10, v9, 2, v10
  v_lshlrev_b32 v11, 1, v10
  v_sub_u32 v12, 0, v11
  v_add_u32 v12, s47, v12
  v_add_u32 v12, 504, v12
  ds_read_b64 v[16:17], v12 offset:3584
  ds_read_b64 v[18:19], v12 offset:3072
  ds_read_b64 v[20:21], v12 offset:2560
  ds_read_b64 v[22:23], v12 offset:2048
  ds_read_b64 v[24:25], v12 offset:1536
  ds_read_b64 v[26:27], v12 offset:1024
  ds_read_b64 v[28:29], v12 offset:512
  ds_read_b64 v[30:31], v12 offset:0
  s_lshl_b32 s52, s44, 12
  s_add_u32 s52, s52, 0xea0000
  s_nop 7
  v_permlane32_swap_b32 v80, v82
  v_permlane32_swap_b32 v81, v83
  v_permlane32_swap_b32 v84, v86
  v_permlane32_swap_b32 v85, v87
  v_permlane32_swap_b32 v88, v90
  v_permlane32_swap_b32 v89, v91
  v_permlane32_swap_b32 v92, v94
  v_permlane32_swap_b32 v93, v95
  v_permlane32_swap_b32 v96, v98
  v_permlane32_swap_b32 v97, v99
  v_permlane32_swap_b32 v100, v102
  v_permlane32_swap_b32 v101, v103
  v_permlane32_swap_b32 v104, v106
  v_permlane32_swap_b32 v105, v107
  v_permlane32_swap_b32 v108, v110
  v_permlane32_swap_b32 v109, v111
  s_waitcnt lgkmcnt(0)
  v_and_b32 v40, 0xffff0000, v17
  v_fma_f32 v80, v40, s56, v80
  v_lshlrev_b32 v41, 16, v17
  v_fma_f32 v82, v41, s56, v82
  v_and_b32 v42, 0xffff0000, v16
  v_fma_f32 v81, v42, s56, v81
  v_lshlrev_b32 v43, 16, v16
  v_fma_f32 v83, v43, s56, v83
  v_cvt_pk_bf16_f32 v112, v80, v82
  v_cvt_pk_bf16_f32 v113, v81, v83
  buffer_store_dwordx2 v[112:113], v11, s[36:39], s52 offen offset:0 sc1
  v_and_b32 v40, 0xffff0000, v19
  v_fma_f32 v84, v40, s56, v84
  v_lshlrev_b32 v41, 16, v19
  v_fma_f32 v86, v41, s56, v86
  v_and_b32 v42, 0xffff0000, v18
  v_fma_f32 v85, v42, s56, v85
  v_lshlrev_b32 v43, 16, v18
  v_fma_f32 v87, v43, s56, v87
  v_cvt_pk_bf16_f32 v114, v84, v86
  v_cvt_pk_bf16_f32 v115, v85, v87
  buffer_store_dwordx2 v[114:115], v11, s[36:39], s52 offen offset:512 sc1
  v_and_b32 v40, 0xffff0000, v21
  v_fma_f32 v88, v40, s56, v88
  v_lshlrev_b32 v41, 16, v21
  v_fma_f32 v90, v41, s56, v90
  v_and_b32 v42, 0xffff0000, v20
  v_fma_f32 v89, v42, s56, v89
  v_lshlrev_b32 v43, 16, v20
  v_fma_f32 v91, v43, s56, v91
  v_cvt_pk_bf16_f32 v116, v88, v90
  v_cvt_pk_bf16_f32 v117, v89, v91
  buffer_store_dwordx2 v[116:117], v11, s[36:39], s52 offen offset:1024 sc1
  v_and_b32 v40, 0xffff0000, v23
  v_fma_f32 v92, v40, s56, v92
  v_lshlrev_b32 v41, 16, v23
  v_fma_f32 v94, v41, s56, v94
  v_and_b32 v42, 0xffff0000, v22
  v_fma_f32 v93, v42, s56, v93
  v_lshlrev_b32 v43, 16, v22
  v_fma_f32 v95, v43, s56, v95
  v_cvt_pk_bf16_f32 v118, v92, v94
  v_cvt_pk_bf16_f32 v119, v93, v95
  buffer_store_dwordx2 v[118:119], v11, s[36:39], s52 offen offset:1536 sc1
  v_and_b32 v40, 0xffff0000, v25
  v_fma_f32 v96, v40, s56, v96
  v_lshlrev_b32 v41, 16, v25
  v_fma_f32 v98, v41, s56, v98
  v_and_b32 v42, 0xffff0000, v24
  v_fma_f32 v97, v42, s56, v97
  v_lshlrev_b32 v43, 16, v24
  v_fma_f32 v99, v43, s56, v99
  v_cvt_pk_bf16_f32 v120, v96, v98
  v_cvt_pk_bf16_f32 v121, v97, v99
  buffer_store_dwordx2 v[120:121], v11, s[36:39], s52 offen offset:2048 sc1
  v_and_b32 v40, 0xffff0000, v27
  v_fma_f32 v100, v40, s56, v100
  v_lshlrev_b32 v41, 16, v27
  v_fma_f32 v102, v41, s56, v102
  v_and_b32 v42, 0xffff0000, v26
  v_fma_f32 v101, v42, s56, v101
  v_lshlrev_b32 v43, 16, v26
  v_fma_f32 v103, v43, s56, v103
  v_cvt_pk_bf16_f32 v122, v100, v102
  v_cvt_pk_bf16_f32 v123, v101, v103
  buffer_store_dwordx2 v[122:123], v11, s[36:39], s52 offen offset:2560 sc1
  v_and_b32 v40, 0xffff0000, v29
  v_fma_f32 v104, v40, s56, v104
  v_lshlrev_b32 v41, 16, v29
  v_fma_f32 v106, v41, s56, v106
  v_and_b32 v42, 0xffff0000, v28
  v_fma_f32 v105, v42, s56, v105
  v_lshlrev_b32 v43, 16, v28
  v_fma_f32 v107, v43, s56, v107
  v_cvt_pk_bf16_f32 v124, v104, v106
  v_cvt_pk_bf16_f32 v125, v105, v107
  buffer_store_dwordx2 v[124:125], v11, s[36:39], s52 offen offset:3072 sc1
  v_and_b32 v40, 0xffff0000, v31
  v_fma_f32 v108, v40, s56, v108
  v_lshlrev_b32 v41, 16, v31
  v_fma_f32 v110, v41, s56, v110
  v_and_b32 v42, 0xffff0000, v30
  v_fma_f32 v109, v42, s56, v109
  v_lshlrev_b32 v43, 16, v30
  v_fma_f32 v111, v43, s56, v111
  v_cvt_pk_bf16_f32 v126, v108, v110
  v_cvt_pk_bf16_f32 v127, v109, v111
  buffer_store_dwordx2 v[126:127], v11, s[36:39], s52 offen offset:3584 sc1
  s_waitcnt vmcnt(0)
  s_mul_hi_u32 s45, s44, 0x1c71c72
  s_add_u32 s45, s45, 140
  s_lshl_b32 s57, s45, 7
  s_add_u32 s57, s57, 0x14c4000
  v_mov_b32 v1, s57
  v_mov_b32 v3, 1
  s_mov_b64 exec, 1
  buffer_atomic_add v3, v1, s[36:39], 0 offen sc1
  s_mov_b64 exec, -1
  s_branch L_fin
L_fin:
L_end:
  s_endpgm
.section .rodata,"a"
.p2align 6
.amdhsa_kernel gated_mix__mha_block__ssm_conv_h3__prompt_kernel
  .amdhsa_next_free_vgpr 168
  .amdhsa_next_free_sgpr 100
  .amdhsa_accum_offset 168
  .amdhsa_group_segment_fixed_size 0
  .amdhsa_kernarg_size 104
  .amdhsa_user_sgpr_count 2
  .amdhsa_user_sgpr_kernarg_segment_ptr 1
  .amdhsa_system_sgpr_workgroup_id_x 1
  .amdhsa_float_denorm_mode_32 3
.end_amdhsa_kernel
```
